```python
import torch

def _softmax(x, axis=-1):
    return torch.softmax(x, dim=axis)
def _gelu(x):
    return torch.nn.functional.gelu(x, approximate="tanh")
def _silu(x):
    return torch.nn.functional.silu(x)
def _sigmoid(x):
    return torch.sigmoid(x)
def _layernorm(x, axis=-1, eps=1e-5):
    m = x.mean(dim=axis, keepdim=True)
    v = x.var(dim=axis, keepdim=True, unbiased=False)
    return (x - m) / torch.sqrt(v + eps)
def _scatter_add(tgt, idx, src, axis=0):
    return tgt.clone().index_add_(axis, idx, src)
def _segment_sum(src, seg, n):
    out = torch.zeros((n,) + src.shape[1:], dtype=src.dtype)
    return out.index_add_(0, seg, src)
def _pad(x, pw):
    flat = tuple(v for pair in reversed(pw) for v in pair)
    return torch.nn.functional.pad(x, flat)

kernel_name = 'sequential_preLN__sliding_local_dilated__glu_gated_swiglu__prompt'

def setup_inputs():

    _w = (lambda a: (lambda t: t.to(torch.bfloat16) if t.is_floating_point() else t)(torch.as_tensor(a)))
    def _A_setup():
        B, S, D = 1, 2048, 640
        return {
            "x": _w((lambda *s: torch.randn(*s, dtype=torch.bfloat16) * 0.05)(B, S, D)),
            "wqkv": _w((lambda *s: torch.randn(*s, dtype=torch.bfloat16) * 0.05)(D, 3 * D)),
            "wo": _w((lambda *s: torch.randn(*s, dtype=torch.bfloat16) * 0.05)(D, D)),
        }
    _A_in = _A_setup()

    def _B_setup():
        B, S, D, F = 1, 2048, 640, 1536
        return {
            "x": _w((lambda *s: torch.randn(*s, dtype=torch.bfloat16) * 0.05)(B, S, D)),
            "w1": _w((lambda *s: torch.randn(*s, dtype=torch.bfloat16) * 0.8)(D, F) * (2.0 / D) ** 0.5),
            "w3": _w((lambda *s: torch.randn(*s, dtype=torch.bfloat16) * 0.8)(D, F) * (2.0 / D) ** 0.5),
            "w2": _w((lambda *s: torch.randn(*s, dtype=torch.bfloat16) * 0.8)(F, D) * (2.0 / F) ** 0.5),
        }
    _B_in = _B_setup()

    return {
        "A_x": _A_in["x"],
        "A_wqkv": _A_in["wqkv"],
        "A_wo": _A_in["wo"],
        "B_x": _B_in["x"],
        "B_w1": _B_in["w1"],
        "B_w3": _B_in["w3"],
        "B_w2": _B_in["w2"],
    }

def reference(A_x, A_wqkv, A_wo, B_x, B_w1, B_w3, B_w2):
    def _A_ref(x, wqkv, wo):
        B, S, D = x.shape
        H = 32; Dh = D // H
        W, dil = 8, 2
        qkv = (lambda x, *d: x.permute(*d))((x @ wqkv).reshape(B, S, 3, H, Dh), 2, 0, 3, 1, 4)
        q, k, v = qkv[0], qkv[1], qkv[2]
        scale = Dh ** -0.5
        pos = torch.arange(S)
        off = torch.arange(W) * dil
        idx = pos[:, None] - off[None, :]
        mask = idx >= 0
        idx_c = torch.where(mask, idx, 0).reshape(-1)
        kg = k[:, :, idx_c, :].reshape(B, H, S, W, Dh)
        vg = v[:, :, idx_c, :].reshape(B, H, S, W, Dh)
        logits = torch.einsum("bhsd,bhswd->bhsw", q, kg) * scale
        logits = torch.where(mask[None, None, :, :], logits, -1e9)
        attn = _softmax(logits, axis=-1)
        o = torch.einsum("bhsw,bhswd->bhsd", attn, vg)
        return (lambda x, *d: x.permute(*d))(o, 0, 2, 1, 3).reshape(B, S, D) @ wo

    def _B_ref(x, w1, w3, w2):
        gate = torch.einsum("bsd,df->bsf", x, w1)
        up = torch.einsum("bsd,df->bsf", x, w3)
        h = _silu(gate) * up
        out = torch.einsum("bsf,fd->bsd", h, w2)
        return out

    x = A_x
    h = x + _A_ref(_layernorm(x, axis=-1), A_wqkv, A_wo)
    h2 = h + _B_ref(_layernorm(h, axis=-1), B_w1, B_w3, B_w2)
    return h2
```

```asm
; @launch grid=(256,1,1) block=(256,1,1) lds=163840
.amdgcn_target "amdgcn-amd-amdhsa--gfx950"
.text
.globl sequential_preLN__sliding_local_dilated__glu_gated_swiglu__prompt_kernel
.p2align 12
.p2align 8
.type sequential_preLN__sliding_local_dilated__glu_gated_swiglu__prompt_kernel,@function
sequential_preLN__sliding_local_dilated__glu_gated_swiglu__prompt_kernel:
    s_cmp_ge_u32 s2, 256
    s_cbranch_scc1 L_end
    s_load_dwordx16 s[64:79], s[0:1], 0
    s_load_dwordx4 s[80:83], s[0:1], 64
    s_getpc_b64 s[16:17]
L_pc:
    s_mov_b32 s18, L_end-L_pc
    s_mov_b32 s19, 0x20000
    s_lshr_b32 s31, s2, 3
    s_lshl_b32 s36, s31, 11
    v_lshlrev_b32 v4, 3, v0
    buffer_load_dword v253, v4, s[16:19], s36 offen
    v_lshrrev_b32 v4, 6, v0
    v_and_b32 v0, 63, v0
    v_readfirstlane_b32 s20, v4
    s_and_b32 s30, s2, 7
    s_and_b32 s22, s31, 7
    s_and_b32 s32, s30, 1
    s_lshl_b32 s32, s32, 3
    s_or_b32 s22, s22, s32
    s_lshr_b32 s30, s30, 1
    s_lshr_b32 s31, s31, 3
    s_lshl_b32 s30, s30, 2
    s_add_u32 s21, s30, s31
    v_lshrrev_b32 v180, 3, v0
    v_and_b32 v181, 7, v0
    s_mul_i32 s34, s2, 3277
    s_lshr_b32 s34, s34, 16
    s_mul_i32 s35, s34, 20
    s_sub_u32 s35, s2, s35
    v_and_b32 v184, 2, v180
    v_xor_b32 v184, v184, v181
    v_lshlrev_b32 v184, 4, v184
    s_movk_i32 s43, 3840
    v_mad_u32_u24 v186, v180, s43, v184
    s_mul_i32 s42, s20, 10
    s_add_u32 s42, s42, s34
    s_mul_i32 s38, s35, 122880
    s_lshl_b32 s36, s42, 7
    s_add_u32 s38, s38, s36
    v_xor_b32 v187, 64, v186
    s_cmp_lt_u32 s2, 200
    s_cselect_b32 s39, 0, 2146435072
    s_or_b32 s38, s38, s39
    s_lshl_b32 s46, s20, 12
    s_add_u32 m0, s46, 65536
    v_add_u32 v187, 29696, v187
    s_cmp_eq_u32 s20, 3
    s_cbranch_scc1 L_p0_ldx
    s_waitcnt lgkmcnt(0)
    s_mov_b32 s12, s66
    s_mov_b32 s13, s67
    s_mov_b32 s14, 2457600
    s_mov_b32 s15, 0x20000
    buffer_load_dwordx4 v186, s[12:15], s38 offen lds
    buffer_load_dwordx4 v187, s[12:15], s38 offen offset:1024 lds
    s_add_u32 s38, s38, 59392
    buffer_load_dwordx4 v186, s[12:15], s38 offen offset:2048 lds
    buffer_load_dwordx4 v187, s[12:15], s38 offen offset:3072 lds
    s_branch L_p0_ldj
L_p0_ldx:
    s_and_b32 s30, s22, 7
    s_lshl_b32 s30, s30, 4
    s_lshr_b32 s31, s22, 3
    s_add_u32 s30, s30, s31
    s_lshl_b32 s31, s21, 7
    s_add_u32 s30, s30, s31
    s_mul_i32 s30, s30, 1280
    v_mul_u32_u24 v185, 2560, v180
    v_lshl_add_u32 v185, v181, 4, v185
    s_waitcnt lgkmcnt(0)
    s_mov_b32 s12, s64
    s_mov_b32 s13, s65
    s_mov_b32 s14, 2621440
    s_mov_b32 s15, 0x20000
    buffer_load_dwordx4 v[64:67], v185, s[12:15], s30 offen offset:0
    buffer_load_dwordx4 v[68:71], v185, s[12:15], s30 offen offset:128
    buffer_load_dwordx4 v[72:75], v185, s[12:15], s30 offen offset:256
    buffer_load_dwordx4 v[76:79], v185, s[12:15], s30 offen offset:384
    buffer_load_dwordx4 v[80:83], v185, s[12:15], s30 offen offset:512
    buffer_load_dwordx4 v[84:87], v185, s[12:15], s30 offen offset:640
    buffer_load_dwordx4 v[88:91], v185, s[12:15], s30 offen offset:768
    buffer_load_dwordx4 v[92:95], v185, s[12:15], s30 offen offset:896
    buffer_load_dwordx4 v[96:99], v185, s[12:15], s30 offen offset:1024
    buffer_load_dwordx4 v[100:103], v185, s[12:15], s30 offen offset:1152
L_p0_ldj:
    s_load_dword s24, s[82:83], 0
    v_and_b32 v1, 15, v0
    v_lshrrev_b32 v2, 4, v0
    v_lshlrev_b32 v3, 4, v0
    s_lshl_b32 s23, s21, 4
    s_add_u32 s23, s23, s22
    s_mov_b32 s4, s82
    s_mov_b32 s5, s83
    s_mov_b32 s6, 27262976
    s_mov_b32 s7, 0x20000
    v_bfe_u32 v206, v0, 2, 2
    v_lshl_add_u32 v207, v2, 3, v206
    v_lshlrev_b32 v207, 7, v207
    v_and_b32 v208, 3, v0
    v_lshl_add_u32 v207, v208, 3, v207
    v_lshrrev_b32 v206, 1, v206
    v_and_b32 v208, 1, v2
    v_lshl_or_b32 v206, v208, 1, v206
    v_add_u32 v207, s46, v207
    v_xor_b32 v208, 0, v206
    v_lshl_add_u32 v188, v208, 5, v207
    v_xor_b32 v208, 1, v206
    v_lshl_add_u32 v189, v208, 5, v207
    v_xor_b32 v208, 2, v206
    v_lshl_add_u32 v190, v208, 5, v207
    v_xor_b32 v208, 3, v206
    v_lshl_add_u32 v191, v208, 5, v207
    v_lshlrev_b32 v192, 4, v1
    s_movk_i32 s36, 30720
    v_mad_u32_u24 v193, v2, s36, v192
    s_mul_i32 s44, s35, 122880
    s_lshl_b32 s36, s42, 10
    s_add_u32 s44, s44, s36
    s_add_u32 s44, s44, 4194304
    s_or_b32 s44, s44, s39
    v_add_u32 v188, 65536, v188
    v_add_u32 v189, 65536, v189
    v_add_u32 v190, 65536, v190
    v_add_u32 v191, 65536, v191
    v_lshrrev_b32 v182, 2, v180
    v_and_b32 v183, 3, v180
    s_and_b32 s30, s20, 1
    s_lshl_b32 s31, s2, 1
    s_add_u32 s30, s30, s31
    s_cmp_lt_u32 s30, 480
    s_cselect_b32 s33, 0, 2146435072
    s_cmp_lt_u32 s20, 2
    s_cbranch_scc0 L_p0_setY
    s_mul_i32 s31, s30, 3277
    s_lshr_b32 s31, s31, 16
    s_mul_i32 s36, s31, 20
    s_sub_u32 s30, s30, s36
    s_mov_b32 s8, s72
    s_mov_b32 s9, s73
    s_mov_b32 s10, 1966080
    s_mov_b32 s11, 0x20000
    s_mov_b32 s12, s74
    s_mov_b32 s13, s75
    s_mov_b32 s14, 1966080
    s_mov_b32 s15, 0x20000
    s_movk_i32 s43, 3072
    v_mad_u32_u24 v206, v183, s43, v184
    s_lshl_b32 s42, s31, 7
    s_or_b32 s42, s42, s33
    s_lshl_b32 s36, s30, 2
    s_add_u32 s36, s36, 0
    s_mul_i32 s37, s36, 6554
    s_lshr_b32 s37, s37, 16
    s_mul_i32 s38, s37, 10
    s_sub_u32 s38, s36, s38
    s_mul_i32 s37, s37, 80
    s_lshr_b32 s39, s38, 2
    s_mul_i32 s39, s39, 16
    s_lshl_b32 s40, s38, 2
    s_add_u32 s39, s39, s40
    s_lshl_b32 s40, s38, 3
    s_cmp_lt_u32 s38, 8
    s_cselect_b32 s39, s39, s40
    s_mov_b32 s41, 49152
    s_cselect_b32 s41, s41, 12288
    s_add_u32 s39, s39, s37
    s_mul_i32 s39, s39, 3072
    s_add_u32 s39, s39, s42
    v_mad_u32_u24 v198, v182, s41, v206
    v_add_u32 v198, s39, v198
    v_mov_b32 v202, v198
    s_lshl_b32 s36, s30, 2
    s_add_u32 s36, s36, 1
    s_mul_i32 s37, s36, 6554
    s_lshr_b32 s37, s37, 16
    s_mul_i32 s38, s37, 10
    s_sub_u32 s38, s36, s38
    s_mul_i32 s37, s37, 80
    s_lshr_b32 s39, s38, 2
    s_mul_i32 s39, s39, 16
    s_lshl_b32 s40, s38, 2
    s_add_u32 s39, s39, s40
    s_lshl_b32 s40, s38, 3
    s_cmp_lt_u32 s38, 8
    s_cselect_b32 s39, s39, s40
    s_mov_b32 s41, 49152
    s_cselect_b32 s41, s41, 12288
    s_add_u32 s39, s39, s37
    s_mul_i32 s39, s39, 3072
    s_add_u32 s39, s39, s42
    v_mad_u32_u24 v199, v182, s41, v206
    v_xor_b32 v199, 64, v199
    v_add_u32 v199, s39, v199
    v_mov_b32 v203, v199
    s_lshl_b32 s36, s30, 2
    s_add_u32 s36, s36, 2
    s_mul_i32 s37, s36, 6554
    s_lshr_b32 s37, s37, 16
    s_mul_i32 s38, s37, 10
    s_sub_u32 s38, s36, s38
    s_mul_i32 s37, s37, 80
    s_lshr_b32 s39, s38, 2
    s_mul_i32 s39, s39, 16
    s_lshl_b32 s40, s38, 2
    s_add_u32 s39, s39, s40
    s_lshl_b32 s40, s38, 3
    s_cmp_lt_u32 s38, 8
    s_cselect_b32 s39, s39, s40
    s_mov_b32 s41, 49152
    s_cselect_b32 s41, s41, 12288
    s_add_u32 s39, s39, s37
    s_mul_i32 s39, s39, 3072
    s_add_u32 s39, s39, s42
    v_mad_u32_u24 v200, v182, s41, v206
    v_add_u32 v200, s39, v200
    v_mov_b32 v204, v200
    s_lshl_b32 s36, s30, 2
    s_add_u32 s36, s36, 3
    s_mul_i32 s37, s36, 6554
    s_lshr_b32 s37, s37, 16
    s_mul_i32 s38, s37, 10
    s_sub_u32 s38, s36, s38
    s_mul_i32 s37, s37, 80
    s_lshr_b32 s39, s38, 2
    s_mul_i32 s39, s39, 16
    s_lshl_b32 s40, s38, 2
    s_add_u32 s39, s39, s40
    s_lshl_b32 s40, s38, 3
    s_cmp_lt_u32 s38, 8
    s_cselect_b32 s39, s39, s40
    s_mov_b32 s41, 49152
    s_cselect_b32 s41, s41, 12288
    s_add_u32 s39, s39, s37
    s_mul_i32 s39, s39, 3072
    s_add_u32 s39, s39, s42
    v_mad_u32_u24 v201, v182, s41, v206
    v_xor_b32 v201, 64, v201
    v_add_u32 v201, s39, v201
    v_mov_b32 v205, v201
    s_mov_b32 s36, 49152
    v_mad_u32_u24 v176, v2, s36, v192
    s_mul_i32 s36, s30, 196608
    s_lshl_b32 s37, s31, 11
    s_add_u32 s36, s36, s37
    s_add_u32 s36, s36, 8388608
    s_or_b32 s36, s36, s33
    s_add_u32 s92, s36, 0
    s_add_u32 s93, s36, 512
    s_add_u32 s94, s36, 1024
    s_add_u32 s95, s36, 1536
    s_add_u32 s96, s36, 256
    s_add_u32 s97, s36, 768
    s_add_u32 s98, s36, 1280
    s_add_u32 s99, s36, 1792
    s_branch L_p0_setJ
L_p0_setY:
    s_mul_i32 s31, s30, 1366
    s_lshr_b32 s31, s31, 16
    s_mul_i32 s36, s31, 48
    s_sub_u32 s30, s30, s36
    s_mov_b32 s8, s76
    s_mov_b32 s9, s77
    s_mov_b32 s10, 1966080
    s_mov_b32 s11, 0x20000
    s_mov_b32 s12, s68
    s_mov_b32 s13, s69
    s_mov_b32 s14, 819200
    s_mov_b32 s15, 0x20000
    v_lshrrev_b32 v206, 1, v180
    v_and_b32 v207, 1, v180
    v_lshl_add_u32 v206, v206, 2, v207
    s_movk_i32 s43, 1280
    v_mad_u32_u24 v206, v206, s43, v184
    v_xor_b32 v207, 64, v206
    s_mul_i32 s38, s30, 40960
    s_lshl_b32 s36, s31, 7
    s_add_u32 s38, s38, s36
    s_or_b32 s38, s38, s33
    s_add_u32 s36, s38, 0
    v_add_u32 v198, s36, v206
    s_add_u32 s36, s38, 2560
    v_add_u32 v199, s36, v207
    s_add_u32 s36, s38, 20480
    v_add_u32 v200, s36, v206
    s_add_u32 s36, s38, 23040
    v_add_u32 v201, s36, v207
    s_movk_i32 s36, 10240
    v_mad_u32_u24 v176, v2, s36, v192
    s_mul_i32 s36, s30, 40960
    s_lshl_b32 s37, s31, 10
    s_add_u32 s36, s36, s37
    s_add_u32 s36, s36, 12582912
    s_or_b32 s36, s36, s33
    s_add_u32 s92, s36, 0
    s_add_u32 s93, s36, 256
    s_add_u32 s94, s36, 512
    s_add_u32 s95, s36, 768
    s_lshl_b32 s36, s20, 8
    s_and_b32 s36, s36, 256
    s_or_b32 s36, s36, s2
    s_cmp_lt_u32 s36, 200
    s_cselect_b32 s33, 0, 2146435072
    s_mul_i32 s36, s35, 13108
    s_lshr_b32 s36, s36, 16
    s_mul_i32 s37, s36, 5
    s_sub_u32 s37, s35, s37
    s_mul_i32 s36, s36, 160
    s_mul_i32 s38, s37, 40
    s_cmp_eq_u32 s37, 4
    s_cselect_b32 s38, 16, s38
    s_cselect_b32 s39, 40, 20
    s_cselect_b32 s40, 20, 8
    s_cselect_b32 s41, 80, 4
    s_add_u32 s38, s38, s36
    s_mul_i32 s38, s38, 1280
    s_mul_i32 s39, s39, 1280
    s_mul_i32 s40, s40, 1280
    s_mul_i32 s41, s41, 1280
    s_lshl_b32 s36, s34, 7
    s_add_u32 s38, s38, s36
    s_or_b32 s38, s38, s33
    v_mad_u32_u24 v206, v183, s43, v184
    v_mad_u32_u24 v206, v182, s41, v206
    v_xor_b32 v207, 64, v206
    v_add_u32 v207, s40, v207
    v_add_u32 v202, s38, v206
    v_add_u32 v203, s38, v207
    v_add_u32 v204, s39, v202
    v_add_u32 v205, s39, v203
    s_mul_i32 s36, s35, 40960
    s_lshl_b32 s37, s34, 10
    s_add_u32 s36, s36, s37
    s_add_u32 s36, s36, 7340032
    s_or_b32 s36, s36, s33
    s_add_u32 s96, s36, 0
    s_add_u32 s97, s36, 256
    s_add_u32 s98, s36, 512
    s_add_u32 s99, s36, 768
L_p0_setJ:
    s_mov_b32 s16, s64
    s_mov_b32 s17, s65
    s_mov_b32 s18, 2621440
    s_mov_b32 s19, 0x20000
    v_bfe_u32 v22, v180, 2, 1
    v_and_b32 v23, 2, v180
    v_or_b32 v22, v22, v23
    v_xor_b32 v22, v22, v181
    v_lshlrev_b32 v22, 4, v22
    s_movk_i32 s30, 2560
    v_mad_u32_u24 v4, v180, s30, v22
    v_xor_b32 v5, 64, v4
    s_and_b32 s31, s20, 1
    s_lshl_b32 s32, s31, 6
    v_xor_b32 v6, s32, v4
    v_add_u32 v5, 19456, v5
    v_cmp_gt_u32 vcc, 8, v0
    v_mov_b32 v23, 2146435072
    s_lshr_b32 s33, s20, 1
    v_cndmask_b32 v6, v6, v23, vcc
    s_lshl_b32 s30, s21, 7
    s_add_u32 s32, s32, s33
    s_add_u32 s32, s32, s30
    s_mul_i32 s40, s32, 1280
    s_add_u32 s49, s40, 38912
    s_add_u32 s30, s30, s31
    s_mul_i32 s30, s30, 1280
    s_lshl_b32 s33, s33, 7
    s_add_u32 s30, s30, s33
    s_sub_u32 s42, s30, 20480
    s_cmp_eq_u32 s21, 0
    s_cselect_b32 s42, 2146435072, s42
    s_lshl_b32 s43, s20, 12
    s_lshl_b32 s48, s20, 10
    v_min_u32 v22, 4, v180
    v_lshlrev_b32 v22, 12, v22
    v_lshl_add_u32 v22, v181, 4, v22
    s_add_u32 s30, s48, 114688
    v_add_u32 v20, s30, v22
    s_lshl_b32 s30, s20, 11
    s_add_u32 s63, s30, 65536
    v_lshrrev_b32 v56, 2, v0
    v_and_b32 v22, 3, v0
    v_lshlrev_b32 v22, 2, v22
    v_lshl_or_b32 v56, v56, 7, v22
    s_lshr_b32 s30, s2, 2
    s_lshl_b32 s30, s30, 7
    s_and_b32 s31, s2, 3
    s_lshl_b32 s31, s31, 2
    s_add_u32 s30, s30, s31
    s_add_u32 s30, s30, 65536
    s_cmp_eq_u32 s20, 0
    s_cselect_b32 s30, s30, 2146435072
    v_mov_b32 v52, 2146435072
    v_writelane_b32 v52, s30, 0
    s_lshr_b32 s26, s22, 3
    s_and_b32 s28, s22, 7
    v_lshlrev_b32 v61, 4, v1
    s_mov_b32 s30, 49152
    v_mad_u32_u24 v60, v2, s30, v61
    s_movk_i32 s30, 10240
    v_mad_u32_u24 v61, v2, s30, v61
    s_lshl_b32 s30, s22, 2
    s_add_u32 s30, s30, s20
    s_mul_i32 s50, s30, 768
    s_add_u32 s50, s50, 8388608
    s_mul_i32 s30, s28, 1280
    s_mul_i32 s51, s20, 204800
    s_add_u32 s51, s51, s30
    s_add_u32 s51, s51, 7340032
    s_mul_i32 s52, s20, 491520
    s_add_u32 s52, s52, s30
    s_add_u32 s52, s52, 12582912
    s_lshl_b32 s30, s21, 7
    s_lshl_b32 s31, s20, 5
    s_add_u32 s30, s30, s31
    s_add_u32 s30, s30, s26
    s_mul_i32 s53, s30, 1280
    s_mul_i32 s31, s28, 160
    s_add_u32 s53, s53, s31
    s_movk_i32 s30, 6554
    s_movk_i32 s31, 2560
    v_add_u32 v62, 0, v0
    v_mul_u32_u24 v63, s30, v62
    v_lshrrev_b32 v63, 16, v63
    v_mul_u32_u24 v57, 10, v63
    v_sub_u32 v57, v62, v57
    v_lshlrev_b32 v57, 4, v57
    v_mad_u32_u24 v57, v63, s31, v57
    v_add_u32 v62, 64, v0
    v_mul_u32_u24 v63, s30, v62
    v_lshrrev_b32 v63, 16, v63
    v_mul_u32_u24 v58, 10, v63
    v_sub_u32 v58, v62, v58
    v_lshlrev_b32 v58, 4, v58
    v_mad_u32_u24 v58, v63, s31, v58
    v_subrev_u32 v58, 1024, v58
    v_add_u32 v62, 128, v0
    v_mul_u32_u24 v63, s30, v62
    v_lshrrev_b32 v63, 16, v63
    v_mul_u32_u24 v59, 10, v63
    v_sub_u32 v59, v62, v59
    v_lshlrev_b32 v59, 4, v59
    v_mad_u32_u24 v59, v63, s31, v59
    v_subrev_u32 v59, 2048, v59
    v_cmp_gt_u32 vcc, 32, v0
    v_mov_b32 v62, 2146435072
    s_nop 0
    v_cndmask_b32 v59, v62, v59, vcc
    s_mul_i32 s54, s20, 3072
    s_lshl_b32 s55, s20, 10
    s_cmp_eq_u32 s20, 3
    s_waitcnt vmcnt(0)
    s_cbranch_scc1 L_p0_stats
    ds_read_b64_tr_b16 v[64:65], v188 offset:0
    ds_read_b64_tr_b16 v[66:67], v188 offset:512
    ds_read_b64_tr_b16 v[68:69], v189 offset:0
    ds_read_b64_tr_b16 v[70:71], v189 offset:512
    ds_read_b64_tr_b16 v[72:73], v190 offset:0
    ds_read_b64_tr_b16 v[74:75], v190 offset:512
    ds_read_b64_tr_b16 v[76:77], v191 offset:0
    ds_read_b64_tr_b16 v[78:79], v191 offset:512
    s_waitcnt lgkmcnt(0)
    buffer_store_dwordx4 v[64:67], v193, s[4:7], s44 offen offset:0 sc1
    buffer_store_dwordx4 v[68:71], v193, s[4:7], s44 offen offset:256 sc1
    buffer_store_dwordx4 v[72:75], v193, s[4:7], s44 offen offset:512 sc1
    buffer_store_dwordx4 v[76:79], v193, s[4:7], s44 offen offset:768 sc1
    s_branch L_p0_aj
L_p0_stats:
    v_mov_b32 v210, 0x3f803f80
    v_mov_b32 v206, 0
    v_mov_b32 v207, 0
    v_mov_b32 v208, 0
    v_mov_b32 v209, 0
    v_dot2c_f32_bf16 v206, v64, v210
    v_dot2c_f32_bf16 v207, v64, v64
    v_dot2c_f32_bf16 v208, v65, v210
    v_dot2c_f32_bf16 v209, v65, v65
    v_dot2c_f32_bf16 v206, v66, v210
    v_dot2c_f32_bf16 v207, v66, v66
    v_dot2c_f32_bf16 v208, v67, v210
    v_dot2c_f32_bf16 v209, v67, v67
    v_dot2c_f32_bf16 v206, v68, v210
    v_dot2c_f32_bf16 v207, v68, v68
    v_dot2c_f32_bf16 v208, v69, v210
    v_dot2c_f32_bf16 v209, v69, v69
    v_dot2c_f32_bf16 v206, v70, v210
    v_dot2c_f32_bf16 v207, v70, v70
    v_dot2c_f32_bf16 v208, v71, v210
    v_dot2c_f32_bf16 v209, v71, v71
    v_dot2c_f32_bf16 v206, v72, v210
    v_dot2c_f32_bf16 v207, v72, v72
    v_dot2c_f32_bf16 v208, v73, v210
    v_dot2c_f32_bf16 v209, v73, v73
    v_dot2c_f32_bf16 v206, v74, v210
    v_dot2c_f32_bf16 v207, v74, v74
    v_dot2c_f32_bf16 v208, v75, v210
    v_dot2c_f32_bf16 v209, v75, v75
    v_dot2c_f32_bf16 v206, v76, v210
    v_dot2c_f32_bf16 v207, v76, v76
    v_dot2c_f32_bf16 v208, v77, v210
    v_dot2c_f32_bf16 v209, v77, v77
    v_dot2c_f32_bf16 v206, v78, v210
    v_dot2c_f32_bf16 v207, v78, v78
    v_dot2c_f32_bf16 v208, v79, v210
    v_dot2c_f32_bf16 v209, v79, v79
    v_dot2c_f32_bf16 v206, v80, v210
    v_dot2c_f32_bf16 v207, v80, v80
    v_dot2c_f32_bf16 v208, v81, v210
    v_dot2c_f32_bf16 v209, v81, v81
    v_dot2c_f32_bf16 v206, v82, v210
    v_dot2c_f32_bf16 v207, v82, v82
    v_dot2c_f32_bf16 v208, v83, v210
    v_dot2c_f32_bf16 v209, v83, v83
    v_dot2c_f32_bf16 v206, v84, v210
    v_dot2c_f32_bf16 v207, v84, v84
    v_dot2c_f32_bf16 v208, v85, v210
    v_dot2c_f32_bf16 v209, v85, v85
    v_dot2c_f32_bf16 v206, v86, v210
    v_dot2c_f32_bf16 v207, v86, v86
    v_dot2c_f32_bf16 v208, v87, v210
    v_dot2c_f32_bf16 v209, v87, v87
    v_dot2c_f32_bf16 v206, v88, v210
    v_dot2c_f32_bf16 v207, v88, v88
    v_dot2c_f32_bf16 v208, v89, v210
    v_dot2c_f32_bf16 v209, v89, v89
    v_dot2c_f32_bf16 v206, v90, v210
    v_dot2c_f32_bf16 v207, v90, v90
    v_dot2c_f32_bf16 v208, v91, v210
    v_dot2c_f32_bf16 v209, v91, v91
    v_dot2c_f32_bf16 v206, v92, v210
    v_dot2c_f32_bf16 v207, v92, v92
    v_dot2c_f32_bf16 v208, v93, v210
    v_dot2c_f32_bf16 v209, v93, v93
    v_dot2c_f32_bf16 v206, v94, v210
    v_dot2c_f32_bf16 v207, v94, v94
    v_dot2c_f32_bf16 v208, v95, v210
    v_dot2c_f32_bf16 v209, v95, v95
    v_dot2c_f32_bf16 v206, v96, v210
    v_dot2c_f32_bf16 v207, v96, v96
    v_dot2c_f32_bf16 v208, v97, v210
    v_dot2c_f32_bf16 v209, v97, v97
    v_dot2c_f32_bf16 v206, v98, v210
    v_dot2c_f32_bf16 v207, v98, v98
    v_dot2c_f32_bf16 v208, v99, v210
    v_dot2c_f32_bf16 v209, v99, v99
    v_dot2c_f32_bf16 v206, v100, v210
    v_dot2c_f32_bf16 v207, v100, v100
    v_dot2c_f32_bf16 v208, v101, v210
    v_dot2c_f32_bf16 v209, v101, v101
    v_dot2c_f32_bf16 v206, v102, v210
    v_dot2c_f32_bf16 v207, v102, v102
    v_dot2c_f32_bf16 v208, v103, v210
    v_dot2c_f32_bf16 v209, v103, v103
    s_lshl_b32 s60, s23, 7
    s_add_u32 s60, s60, 393216
    v_lshlrev_b32 v211, 4, v180
    v_add_f32 v206, v206, v208
    v_add_f32 v207, v207, v209
    s_nop 0
    v_add_f32_dpp v206, v206, v206 quad_perm:[1,0,3,2] row_mask:0xf bank_mask:0xf
    v_add_f32_dpp v207, v207, v207 quad_perm:[1,0,3,2] row_mask:0xf bank_mask:0xf
    s_nop 0
    v_add_f32_dpp v206, v206, v206 quad_perm:[2,3,0,1] row_mask:0xf bank_mask:0xf
    v_add_f32_dpp v207, v207, v207 quad_perm:[2,3,0,1] row_mask:0xf bank_mask:0xf
    s_nop 0
    v_add_f32_dpp v206, v206, v206 row_half_mirror row_mask:0xf bank_mask:0xf
    v_add_f32_dpp v207, v207, v207 row_half_mirror row_mask:0xf bank_mask:0xf
    v_mul_f32 v206, 0xbacccccd, v206
    v_mul_f32 v207, 0x3acccccd, v207
    v_fma_f32 v207, -v206, v206, v207
    v_max_f32 v207, 0, v207
    v_add_f32 v207, 0x3727c5ac, v207
    v_rsq_f32 v207, v207
    s_mov_b32 exec_lo, 0x01010101
    s_mov_b32 exec_hi, 0x01010101
    buffer_store_dwordx4 v[206:209], v211, s[4:7], s60 offen sc1
    s_mov_b64 exec, -1
    s_nop 1
L_p0_aj:
    s_bitcmp1_b32 s2, 3
    s_cbranch_scc1 L_p0_q1
    s_lshl_b32 s58, s20, 13
    s_add_u32 m0, s58, 135168
    s_nop 0
    buffer_load_dwordx4 v198, s[8:11], 0 offen lds
    s_add_u32 m0, s58, 136192
    s_nop 0
    buffer_load_dwordx4 v199, s[8:11], 0 offen lds
    s_add_u32 m0, s58, 137216
    s_nop 0
    buffer_load_dwordx4 v200, s[8:11], 0 offen lds
    s_add_u32 m0, s58, 138240
    s_nop 0
    buffer_load_dwordx4 v201, s[8:11], 0 offen lds
    s_add_u32 m0, s58, 139264
    s_nop 0
    buffer_load_dwordx4 v202, s[12:15], 0 offen lds
    s_add_u32 m0, s58, 140288
    s_nop 0
    buffer_load_dwordx4 v203, s[12:15], 0 offen lds
    s_add_u32 m0, s58, 141312
    s_nop 0
    buffer_load_dwordx4 v204, s[12:15], 0 offen lds
    s_add_u32 m0, s58, 142336
    s_nop 0
    buffer_load_dwordx4 v205, s[12:15], 0 offen lds
    buffer_load_dword v252, v56, s[4:7], s63 offen
    s_branch L_p0_j1
L_p0_q1:
    s_add_u32 m0, s48, 114688
    s_nop 0
    buffer_load_dwordx4 v6, s[16:19], s42 offen offset:0 lds
    s_add_u32 m0, s48, 118528
    s_nop 0
    buffer_load_dwordx4 v6, s[16:19], s42 offen offset:256 lds
    s_add_u32 m0, s48, 122368
    s_nop 0
    buffer_load_dwordx4 v6, s[16:19], s42 offen offset:512 lds
    s_add_u32 m0, s48, 126208
    s_nop 0
    buffer_load_dwordx4 v6, s[16:19], s42 offen offset:768 lds
    s_add_u32 m0, s48, 130048
    s_nop 0
    buffer_load_dwordx4 v6, s[16:19], s42 offen offset:1024 lds
    s_add_u32 m0, s43, 0
    s_nop 0
    buffer_load_dwordx4 v4, s[16:19], s40 offen offset:0 lds
    buffer_load_dwordx4 v5, s[16:19], s40 offen offset:1024 lds
    s_add_u32 s40, s40, 128
    buffer_load_dwordx4 v4, s[16:19], s49 offen offset:2048 lds
    buffer_load_dwordx4 v5, s[16:19], s49 offen offset:3072 lds
    s_add_u32 s49, s49, 128
L_p0_j1:
    s_waitcnt lgkmcnt(0)
    s_add_u32 s24, s24, 2654435760
    s_lshl_b32 s31, s20, 12
    s_add_u32 s31, s31, 69632
    v_add_u32 v188, s31, v188
    v_add_u32 v189, s31, v189
    v_add_u32 v190, s31, v190
    v_add_u32 v191, s31, v191
    s_lshl_b32 s36, s2, 7
    s_add_u32 s36, s36, 32768
    s_cmp_eq_u32 s20, 0
    s_cselect_b32 s59, s36, 2146435072
    v_mov_b32 v55, s24
    v_lshlrev_b32 v209, 2, v0
    s_and_b32 s37, s20, 1
    s_lshr_b32 s38, s20, 1
    s_mul_i32 s30, s22, 40
    s_lshr_b32 s31, s30, 6
    s_add_u32 s30, s30, 39
    s_lshr_b32 s30, s30, 6
    s_mul_i32 s31, s31, 20
    s_mul_i32 s30, s30, 20
    s_add_u32 s30, s30, 19
    s_mul_i32 s32, s20, 10
    s_add_u32 s31, s31, s32
    v_min_u32 v19, 9, v0
    v_add_u32 v19, s31, v19
    v_min_u32 v19, s30, v19
    v_lshlrev_b32 v19, 7, v19
    s_mul_i32 s41, s22, 640
    s_add_u32 s41, s41, 4194304
    s_lshl_b32 s30, s21, 1
    s_add_u32 s30, s30, s37
    s_lshl_b32 s30, s30, 10
    s_add_u32 s57, s30, 393216
    s_add_u32 s61, s30, 391936
    s_cmp_eq_u32 s21, 0
    s_cselect_b32 s61, 2146435072, s61
    s_cselect_b32 s39, 0xf149f2ca, 0
    s_lshl_b32 s31, s20, 8
    s_movk_i32 s34, 1639
    s_movk_i32 s35, 9600
    v_add_u32 v22, s31, v0
    v_lshlrev_b32 v25, 4, v22
    v_mul_u32_u24 v24, s34, v22
    v_lshrrev_b32 v24, 16, v24
    v_mad_u32_u24 v7, v24, s35, v25
    v_add_u32 v22, 64, v22
    v_mul_u32_u24 v24, s34, v22
    v_lshrrev_b32 v24, 16, v24
    v_mad_u32_u24 v8, v24, s35, v25
    v_add_u32 v22, 64, v22
    v_mul_u32_u24 v24, s34, v22
    v_lshrrev_b32 v24, 16, v24
    v_mad_u32_u24 v9, v24, s35, v25
    v_add_u32 v22, 64, v22
    v_mul_u32_u24 v24, s34, v22
    v_lshrrev_b32 v24, 16, v24
    v_mad_u32_u24 v10, v24, s35, v25
    s_cmp_eq_u32 s20, 3
    s_cselect_b32 s31, 2146435072, 0
    v_or_b32 v10, s31, v10
    v_and_b32 v23, 1, v2
    v_lshrrev_b32 v24, 1, v2
    v_lshl_or_b32 v23, v23, 1, v24
    v_bfe_u32 v24, v1, 2, 1
    v_and_b32 v25, 2, v1
    v_or_b32 v24, v24, v25
    v_lshrrev_b32 v25, 3, v1
    v_lshl_or_b32 v24, v25, 2, v24
    v_xor_b32 v24, v24, v23
    v_lshlrev_b32 v24, 4, v24
    v_lshl_add_u32 v24, v1, 7, v24
    s_lshl_b32 s31, s37, 6
    v_xor_b32 v24, s31, v24
    s_lshl_b32 s31, s37, 13
    v_add_u32 v11, s31, v24
    v_xor_b32 v12, 64, v11
    s_xor_b32 s31, s37, 1
    s_mul_i32 s31, s31, 1088
    v_xor_b32 v13, s31, v24
    v_add_u32 v13, 114688, v13
    v_add_u32 v14, s43, v3
    v_xor_b32 v26, 4224, v14
    v_add_u32 v14, 140288, v14
    v_add_u32 v26, 140288, v26
    v_lshlrev_b32 v21, 4, v1
    v_mul_u32_u24 v23, 1920, v23
    s_mul_i32 s31, s38, 320
    s_mul_i32 s32, s37, 7680
    s_add_u32 s31, s31, s32
    s_lshl_b32 s32, s32, 1
    s_sub_u32 s36, 7680, s32
    v_add_u32 v23, s31, v23
    v_lshl_add_u32 v23, v1, 4, v23
    v_cmp_gt_u32 vcc, 4, v1
    v_add_u32 v232, 65536, v23
    v_add_u32 v233, 66176, v23
    v_mov_b32 v24, 66752
    v_mov_b32 v25, 65792
    v_cndmask_b32 v24, v24, v25, vcc
    v_add_u32 v234, v24, v23
    v_mov_b32 v24, 66944
    v_mov_b32 v25, 66432
    v_cndmask_b32 v24, v24, v25, vcc
    v_cmp_le_u32 vcc, 12, v1
    v_mov_b32 v25, 66880
    v_lshlrev_b32 v22, 2, v2
    v_cndmask_b32 v24, v24, v25, vcc
    v_add_u32 v235, v24, v23
    v_add_u32 v236, s36, v232
    v_add_u32 v237, s36, v233
    v_add_u32 v238, s36, v234
    v_add_u32 v239, s36, v235
    v_sub_u32 v22, v1, v22
    v_mov_b32 v23, 0xf149f2ca
    v_subrev_u32 v24, 0, v22
    v_cmp_gt_u32 s[30:31], 8, v24
    v_cmp_ge_i32 s[32:33], -9, v24
    v_ashrrev_i32 v120, 31, v24
    v_mov_b32 v40, 0x3f803f80
    v_cndmask_b32 v28, v23, 0, s[30:31]
    v_cndmask_b32 v32, v23, 0, s[32:33]
    v_min_f32 v36, s39, v32
    v_subrev_u32 v24, 1, v22
    v_cmp_gt_u32 s[30:31], 8, v24
    v_cmp_ge_i32 s[32:33], -9, v24
    v_ashrrev_i32 v121, 31, v24
    v_mov_b32 v41, 0x3f803f80
    v_cndmask_b32 v29, v23, 0, s[30:31]
    v_cndmask_b32 v33, v23, 0, s[32:33]
    v_min_f32 v37, s39, v33
    v_subrev_u32 v24, 2, v22
    v_cmp_gt_u32 s[30:31], 8, v24
    v_cmp_ge_i32 s[32:33], -9, v24
    v_ashrrev_i32 v122, 31, v24
    v_mov_b32 v42, 0x3f803f80
    v_cndmask_b32 v30, v23, 0, s[30:31]
    v_cndmask_b32 v34, v23, 0, s[32:33]
    v_min_f32 v38, s39, v34
    v_subrev_u32 v24, 3, v22
    v_cmp_gt_u32 s[30:31], 8, v24
    v_cmp_ge_i32 s[32:33], -9, v24
    v_ashrrev_i32 v123, 31, v24
    v_mov_b32 v43, 0x3f803f80
    v_cndmask_b32 v31, v23, 0, s[30:31]
    v_cndmask_b32 v35, v23, 0, s[32:33]
    v_min_f32 v39, s39, v35
    s_mov_b32 s31, 0xffff
    v_bfi_b32 v44, s31, v120, v121
    v_bfi_b32 v45, s31, v122, v123
    v_cmp_eq_u32 vcc, 0, v2
    s_mul_i32 s30, s20, 6400
    s_add_u32 s30, s30, 114688
    v_cndmask_b32 v49, 0, -1, vcc
    v_lshl_add_u32 v22, v2, 6, v3
    v_add_u32 v46, s30, v22
    v_lshrrev_b32 v22, 2, v0
    v_lshl_add_u32 v22, v22, 4, s30
    v_and_b32 v23, 3, v0
    v_lshlrev_b32 v23, 3, v23
    s_mov_b32 s32, 1347451177
    s_mov_b32 s33, 673720401
    v_bfe_u32 v24, s32, v23, 8
    v_lshl_add_u32 v47, v24, 3, v22
    v_bfe_u32 v24, s33, v23, 8
    v_lshl_add_u32 v48, v24, 3, v22
    v_mov_b32 v23, 2146435072
    v_cmp_gt_u32 s[30:31], 32, v0
    v_cmp_eq_u32 vcc, 2, v2
    v_lshlrev_b32 v22, 3, v1
    v_cndmask_b32 v50, v23, v3, s[30:31]
    v_cndmask_b32 v51, v23, v22, vcc
    s_lshl_b32 s30, s21, 1
    s_add_u32 s30, s30, s37
    s_mul_i32 s30, s30, 81920
    s_add_u32 s30, s30, 14680064
    s_lshl_b32 s31, s22, 1
    s_add_u32 s31, s31, s38
    s_lshl_b32 s32, s31, 9
    s_add_u32 s45, s30, s32
    s_lshl_b32 s32, s31, 7
    s_add_u32 s47, s30, s32
    s_add_u32 s47, s47, 16384
    s_mov_b32 s46, 0x3ea52b5c
    s_cmp_eq_u32 s20, 3
    s_cbranch_scc1 L_p0_now
    s_waitcnt vmcnt(9)
L_p0_now:
    s_barrier
    s_mov_b32 exec_hi, 0
    buffer_store_dword v55, v209, s[4:7], s59 offen sc1
    s_mov_b32 exec_hi, -1
    s_bitcmp1_b32 s2, 3
    s_cbranch_scc1 L_p0_q2
    s_add_u32 m0, s48, 114688
    s_nop 0
    buffer_load_dwordx4 v6, s[16:19], s42 offen offset:0 lds
    s_add_u32 m0, s48, 118528
    s_nop 0
    buffer_load_dwordx4 v6, s[16:19], s42 offen offset:256 lds
    s_add_u32 m0, s48, 122368
    s_nop 0
    buffer_load_dwordx4 v6, s[16:19], s42 offen offset:512 lds
    s_add_u32 m0, s48, 126208
    s_nop 0
    buffer_load_dwordx4 v6, s[16:19], s42 offen offset:768 lds
    s_add_u32 m0, s48, 130048
    s_nop 0
    buffer_load_dwordx4 v6, s[16:19], s42 offen offset:1024 lds
    s_add_u32 m0, s43, 0
    s_nop 0
    buffer_load_dwordx4 v4, s[16:19], s40 offen offset:0 lds
    buffer_load_dwordx4 v5, s[16:19], s40 offen offset:1024 lds
    s_add_u32 s40, s40, 128
    buffer_load_dwordx4 v4, s[16:19], s49 offen offset:2048 lds
    buffer_load_dwordx4 v5, s[16:19], s49 offen offset:3072 lds
    s_add_u32 s49, s49, 128
    s_add_u32 m0, s43, 16384
    s_nop 0
    buffer_load_dwordx4 v4, s[16:19], s40 offen offset:0 lds
    buffer_load_dwordx4 v5, s[16:19], s40 offen offset:1024 lds
    s_add_u32 s40, s40, 128
    buffer_load_dwordx4 v4, s[16:19], s49 offen offset:2048 lds
    buffer_load_dwordx4 v5, s[16:19], s49 offen offset:3072 lds
    s_add_u32 s49, s49, 128
    s_add_u32 m0, s43, 32768
    s_nop 0
    buffer_load_dwordx4 v4, s[16:19], s40 offen offset:0 lds
    buffer_load_dwordx4 v5, s[16:19], s40 offen offset:1024 lds
    s_add_u32 s40, s40, 128
    buffer_load_dwordx4 v4, s[16:19], s49 offen offset:2048 lds
    buffer_load_dwordx4 v5, s[16:19], s49 offen offset:3072 lds
    s_add_u32 s49, s49, 128
    s_add_u32 m0, s43, 49152
    s_nop 0
    buffer_load_dwordx4 v4, s[16:19], s40 offen offset:0 lds
    buffer_load_dwordx4 v5, s[16:19], s40 offen offset:1024 lds
    s_add_u32 s40, s40, 128
    buffer_load_dwordx4 v4, s[16:19], s49 offen offset:2048 lds
    buffer_load_dwordx4 v5, s[16:19], s49 offen offset:3072 lds
    s_add_u32 s49, s49, 128
    s_branch L_p0_j2
L_p0_q2:
    s_add_u32 m0, s43, 16384
    s_nop 0
    buffer_load_dwordx4 v4, s[16:19], s40 offen offset:0 lds
    buffer_load_dwordx4 v5, s[16:19], s40 offen offset:1024 lds
    s_add_u32 s40, s40, 128
    buffer_load_dwordx4 v4, s[16:19], s49 offen offset:2048 lds
    buffer_load_dwordx4 v5, s[16:19], s49 offen offset:3072 lds
    s_add_u32 s49, s49, 128
    s_add_u32 m0, s43, 32768
    s_nop 0
    buffer_load_dwordx4 v4, s[16:19], s40 offen offset:0 lds
    buffer_load_dwordx4 v5, s[16:19], s40 offen offset:1024 lds
    s_add_u32 s40, s40, 128
    buffer_load_dwordx4 v4, s[16:19], s49 offen offset:2048 lds
    buffer_load_dwordx4 v5, s[16:19], s49 offen offset:3072 lds
    s_add_u32 s49, s49, 128
    s_add_u32 m0, s43, 49152
    s_nop 0
    buffer_load_dwordx4 v4, s[16:19], s40 offen offset:0 lds
    buffer_load_dwordx4 v5, s[16:19], s40 offen offset:1024 lds
    s_add_u32 s40, s40, 128
    buffer_load_dwordx4 v4, s[16:19], s49 offen offset:2048 lds
    buffer_load_dwordx4 v5, s[16:19], s49 offen offset:3072 lds
    s_add_u32 s49, s49, 128
    s_lshl_b32 s58, s20, 13
    s_add_u32 m0, s58, 135168
    s_nop 0
    buffer_load_dwordx4 v198, s[8:11], 0 offen lds
    s_add_u32 m0, s58, 136192
    s_nop 0
    buffer_load_dwordx4 v199, s[8:11], 0 offen lds
    s_add_u32 m0, s58, 137216
    s_nop 0
    buffer_load_dwordx4 v200, s[8:11], 0 offen lds
    s_add_u32 m0, s58, 138240
    s_nop 0
    buffer_load_dwordx4 v201, s[8:11], 0 offen lds
    s_add_u32 m0, s58, 139264
    s_nop 0
    buffer_load_dwordx4 v202, s[12:15], 0 offen lds
    s_add_u32 m0, s58, 140288
    s_nop 0
    buffer_load_dwordx4 v203, s[12:15], 0 offen lds
    s_add_u32 m0, s58, 141312
    s_nop 0
    buffer_load_dwordx4 v204, s[12:15], 0 offen lds
    s_add_u32 m0, s58, 142336
    s_nop 0
    buffer_load_dwordx4 v205, s[12:15], 0 offen lds
    buffer_load_dword v252, v56, s[4:7], s63 offen
L_p0_j2:
    s_mov_b32 s62, 32768
    s_mov_b64 exec, 0
    s_cmp_eq_u32 s20, 0
    s_cbranch_scc1 L_hop0
    s_cmp_eq_u32 s20, 1
    s_cbranch_scc1 L_hop1
    s_cmp_eq_u32 s20, 2
    s_cbranch_scc1 L_hop2
    s_branch L_hop3
L_hopret:
    s_mov_b64 exec, -1
    buffer_load_dword v24, v19, s[4:7], s62 offen sc1
    s_waitcnt vmcnt(0)
    v_cmp_ne_u32 vcc, s24, v24
    s_nop 0
    s_cbranch_vccnz L_g0
L_gx0:
    ds_write_b128 v20, v[40:43]
    s_barrier
    s_add_u32 m0, s43, 65536
    s_nop 0
    buffer_load_dwordx4 v7, s[4:7], s41 offen offset:0 sc1 lds
    buffer_load_dwordx4 v8, s[4:7], s41 offen offset:1024 sc1 lds
    buffer_load_dwordx4 v9, s[4:7], s41 offen offset:2048 sc1 lds
    buffer_load_dwordx4 v10, s[4:7], s41 offen offset:3072 sc1 lds
    s_add_u32 s41, s41, 245760
    s_add_u32 m0, s43, 81920
    s_nop 0
    buffer_load_dwordx4 v7, s[4:7], s41 offen offset:0 sc1 lds
    buffer_load_dwordx4 v8, s[4:7], s41 offen offset:1024 sc1 lds
    buffer_load_dwordx4 v9, s[4:7], s41 offen offset:2048 sc1 lds
    buffer_load_dwordx4 v10, s[4:7], s41 offen offset:3072 sc1 lds
    s_add_u32 s41, s41, 245760
    v_and_b32 v208, 2, v0
    v_cmp_eq_u32 vcc, 0, v208
    ds_read_b64_tr_b16 v[144:145], v188 offset:0
    ds_read_b64_tr_b16 v[146:147], v188 offset:512
    ds_read_b64_tr_b16 v[148:149], v189 offset:0
    ds_read_b64_tr_b16 v[150:151], v189 offset:512
    ds_read_b64_tr_b16 v[152:153], v190 offset:0
    ds_read_b64_tr_b16 v[154:155], v190 offset:512
    ds_read_b64_tr_b16 v[156:157], v191 offset:0
    ds_read_b64_tr_b16 v[158:159], v191 offset:512
    ds_read_b64_tr_b16 v[160:161], v188 offset:4096
    ds_read_b64_tr_b16 v[162:163], v188 offset:4608
    ds_read_b64_tr_b16 v[164:165], v189 offset:4096
    ds_read_b64_tr_b16 v[166:167], v189 offset:4608
    ds_read_b64_tr_b16 v[168:169], v190 offset:4096
    ds_read_b64_tr_b16 v[170:171], v190 offset:4608
    ds_read_b64_tr_b16 v[172:173], v191 offset:4096
    ds_read_b64_tr_b16 v[174:175], v191 offset:4608
    s_waitcnt lgkmcnt(0)
    s_cmp_lt_u32 s20, 2
    s_cbranch_scc0 L_p0_join
    v_mov_b32_dpp v120, v144 quad_perm:[2,3,2,3] row_mask:0xf bank_mask:0xf
    v_mov_b32_dpp v121, v145 quad_perm:[2,3,2,3] row_mask:0xf bank_mask:0xf
    v_mov_b32_dpp v122, v146 quad_perm:[2,3,2,3] row_mask:0xf bank_mask:0xf
    v_mov_b32_dpp v123, v147 quad_perm:[2,3,2,3] row_mask:0xf bank_mask:0xf
    v_mov_b32_dpp v124, v148 quad_perm:[2,3,2,3] row_mask:0xf bank_mask:0xf
    v_mov_b32_dpp v125, v149 quad_perm:[2,3,2,3] row_mask:0xf bank_mask:0xf
    v_mov_b32_dpp v126, v150 quad_perm:[2,3,2,3] row_mask:0xf bank_mask:0xf
    v_mov_b32_dpp v127, v151 quad_perm:[2,3,2,3] row_mask:0xf bank_mask:0xf
    v_mov_b32_dpp v128, v152 quad_perm:[2,3,2,3] row_mask:0xf bank_mask:0xf
    v_mov_b32_dpp v129, v153 quad_perm:[2,3,2,3] row_mask:0xf bank_mask:0xf
    v_mov_b32_dpp v130, v154 quad_perm:[2,3,2,3] row_mask:0xf bank_mask:0xf
    v_mov_b32_dpp v131, v155 quad_perm:[2,3,2,3] row_mask:0xf bank_mask:0xf
    v_mov_b32_dpp v132, v156 quad_perm:[2,3,2,3] row_mask:0xf bank_mask:0xf
    v_mov_b32_dpp v133, v157 quad_perm:[2,3,2,3] row_mask:0xf bank_mask:0xf
    v_mov_b32_dpp v134, v158 quad_perm:[2,3,2,3] row_mask:0xf bank_mask:0xf
    v_mov_b32_dpp v135, v159 quad_perm:[2,3,2,3] row_mask:0xf bank_mask:0xf
    v_cndmask_b32_dpp v144, v160, v144, vcc quad_perm:[0,1,0,1] row_mask:0xf bank_mask:0xf
    v_cndmask_b32_dpp v145, v161, v145, vcc quad_perm:[0,1,0,1] row_mask:0xf bank_mask:0xf
    v_cndmask_b32_dpp v146, v162, v146, vcc quad_perm:[0,1,0,1] row_mask:0xf bank_mask:0xf
    v_cndmask_b32_dpp v147, v163, v147, vcc quad_perm:[0,1,0,1] row_mask:0xf bank_mask:0xf
    v_cndmask_b32_dpp v148, v164, v148, vcc quad_perm:[0,1,0,1] row_mask:0xf bank_mask:0xf
    v_cndmask_b32_dpp v149, v165, v149, vcc quad_perm:[0,1,0,1] row_mask:0xf bank_mask:0xf
    v_cndmask_b32_dpp v150, v166, v150, vcc quad_perm:[0,1,0,1] row_mask:0xf bank_mask:0xf
    v_cndmask_b32_dpp v151, v167, v151, vcc quad_perm:[0,1,0,1] row_mask:0xf bank_mask:0xf
    v_cndmask_b32_dpp v152, v168, v152, vcc quad_perm:[0,1,0,1] row_mask:0xf bank_mask:0xf
    v_cndmask_b32_dpp v153, v169, v153, vcc quad_perm:[0,1,0,1] row_mask:0xf bank_mask:0xf
    v_cndmask_b32_dpp v154, v170, v154, vcc quad_perm:[0,1,0,1] row_mask:0xf bank_mask:0xf
    v_cndmask_b32_dpp v155, v171, v155, vcc quad_perm:[0,1,0,1] row_mask:0xf bank_mask:0xf
    v_cndmask_b32_dpp v156, v172, v156, vcc quad_perm:[0,1,0,1] row_mask:0xf bank_mask:0xf
    v_cndmask_b32_dpp v157, v173, v157, vcc quad_perm:[0,1,0,1] row_mask:0xf bank_mask:0xf
    v_cndmask_b32_dpp v158, v174, v158, vcc quad_perm:[0,1,0,1] row_mask:0xf bank_mask:0xf
    v_cndmask_b32_dpp v159, v175, v159, vcc quad_perm:[0,1,0,1] row_mask:0xf bank_mask:0xf
    v_cndmask_b32 v160, v160, v120, vcc
    v_cndmask_b32 v161, v161, v121, vcc
    v_cndmask_b32 v162, v162, v122, vcc
    v_cndmask_b32 v163, v163, v123, vcc
    v_cndmask_b32 v164, v164, v124, vcc
    v_cndmask_b32 v165, v165, v125, vcc
    v_cndmask_b32 v166, v166, v126, vcc
    v_cndmask_b32 v167, v167, v127, vcc
    v_cndmask_b32 v168, v168, v128, vcc
    v_cndmask_b32 v169, v169, v129, vcc
    v_cndmask_b32 v170, v170, v130, vcc
    v_cndmask_b32 v171, v171, v131, vcc
    v_cndmask_b32 v172, v172, v132, vcc
    v_cndmask_b32 v173, v173, v133, vcc
    v_cndmask_b32 v174, v174, v134, vcc
    v_cndmask_b32 v175, v175, v135, vcc
L_p0_join:
    s_lshl_b32 s30, s23, 7
    s_add_u32 s30, s30, 98304
    s_cmp_eq_u32 s20, 0
    s_cselect_b32 s30, s30, 2146435072
    v_lshrrev_b32 v53, 5, v0
    v_lshlrev_b32 v53, 30, v53
    v_lshl_or_b32 v53, v0, 2, v53
    v_add_u32 v53, s30, v53
    s_waitcnt vmcnt(4)
    s_barrier
    ds_read_b128 a[188:191], v232 offset:0
    ds_read_b128 a[168:171], v13 offset:0
    ds_read_b128 a[192:195], v233 offset:0
    ds_read_b128 a[196:199], v234 offset:0
    ds_read_b128 a[200:203], v235 offset:0
    ds_read_b128 a[172:175], v11 offset:0
    ds_read_b128 a[176:179], v11 offset:2048
    ds_read_b128 a[180:183], v11 offset:4096
    ds_read_b128 a[184:187], v11 offset:6144
    s_waitcnt lgkmcnt(7)
    v_mfma_f32_16x16x32_bf16 v[64:67], a[188:191], a[168:171], 0
    s_add_u32 m0, s43, 98304
    ds_read_b128 a[236:239], v239 offset:0
    s_waitcnt lgkmcnt(7)
    v_mfma_f32_16x16x32_bf16 v[84:87], a[192:195], a[168:171], 0
    ds_read_b128 a[208:211], v12 offset:0
    s_waitcnt lgkmcnt(7)
    v_mfma_f32_16x16x32_bf16 v[104:107], a[196:199], a[168:171], 0
    ds_read_b128 a[232:235], v238 offset:0
    s_waitcnt lgkmcnt(7)
    v_mfma_f32_16x16x32_bf16 v[124:127], a[200:203], a[168:171], 0
    buffer_load_dwordx4 v7, s[4:7], s41 offen offset:0 sc1 lds
    s_waitcnt lgkmcnt(6)
    v_mfma_f32_16x16x32_bf16 v[128:131], a[200:203], a[172:175], 0
    s_add_u32 m0, s43, 98304
    ds_read_b128 a[228:231], v237 offset:0
    v_mfma_f32_16x16x32_bf16 v[108:111], a[196:199], a[172:175], 0
    ds_read_b128 a[224:227], v236 offset:0
    v_mfma_f32_16x16x32_bf16 v[88:91], a[192:195], a[172:175], 0
    buffer_load_dwordx4 v8, s[4:7], s41 offen offset:1024 sc1 lds
    v_mfma_f32_16x16x32_bf16 v[68:71], a[188:191], a[172:175], 0
    s_add_u32 m0, s43, 98304
    ds_read_b128 a[212:215], v12 offset:2048
    s_waitcnt lgkmcnt(8)
    v_mfma_f32_16x16x32_bf16 v[72:75], a[188:191], a[176:179], 0
    ds_read_b128 a[216:219], v12 offset:4096
    v_mfma_f32_16x16x32_bf16 v[92:95], a[192:195], a[176:179], 0
    ds_read_b128 a[220:223], v12 offset:6144
    v_mfma_f32_16x16x32_bf16 v[112:115], a[196:199], a[176:179], 0
    buffer_load_dwordx4 v9, s[4:7], s41 offen offset:2048 sc1 lds
    v_mfma_f32_16x16x32_bf16 v[132:135], a[200:203], a[176:179], 0
    s_add_u32 m0, s43, 98304
    s_waitcnt lgkmcnt(9)
    v_mfma_f32_16x16x32_bf16 v[136:139], a[200:203], a[180:183], 0
    buffer_load_dwordx4 v10, s[4:7], s41 offen offset:3072 sc1 lds
    v_mfma_f32_16x16x32_bf16 v[116:119], a[196:199], a[180:183], 0
    s_add_u32 s41, s41, 245760
    v_mfma_f32_16x16x32_bf16 v[96:99], a[192:195], a[180:183], 0
    buffer_store_dwordx4 v[144:147], v176, s[4:7], s92 offen sc1
    v_mfma_f32_16x16x32_bf16 v[76:79], a[188:191], a[180:183], 0
    s_waitcnt lgkmcnt(8)
    v_mfma_f32_16x16x32_bf16 v[80:83], a[188:191], a[184:187], 0
    v_mfma_f32_16x16x32_bf16 v[100:103], a[192:195], a[184:187], 0
    v_mfma_f32_16x16x32_bf16 v[120:123], a[196:199], a[184:187], 0
    buffer_store_dwordx4 v[148:151], v176, s[4:7], s93 offen sc1
    v_mfma_f32_16x16x32_bf16 v[140:143], a[200:203], a[184:187], 0
    s_waitcnt lgkmcnt(0)
    v_mfma_f32_16x16x32_bf16 v[128:131], a[236:239], a[208:211], v[128:131]
    s_waitcnt vmcnt(6)
    s_barrier
    v_mfma_f32_16x16x32_bf16 v[108:111], a[232:235], a[208:211], v[108:111]
    ds_read_b128 a[188:191], v232 offset:16384
    v_mfma_f32_16x16x32_bf16 v[88:91], a[228:231], a[208:211], v[88:91]
    ds_read_b128 a[168:171], v13 offset:2048
    v_mfma_f32_16x16x32_bf16 v[68:71], a[224:227], a[208:211], v[68:71]
    ds_read_b128 a[192:195], v233 offset:16384
    v_mfma_f32_16x16x32_bf16 v[72:75], a[224:227], a[212:215], v[72:75]
    ds_read_b128 a[196:199], v234 offset:16384
    v_mfma_f32_16x16x32_bf16 v[92:95], a[228:231], a[212:215], v[92:95]
    ds_read_b128 a[200:203], v235 offset:16384
    v_mfma_f32_16x16x32_bf16 v[112:115], a[232:235], a[212:215], v[112:115]
    ds_read_b128 a[172:175], v11 offset:16384
    v_mfma_f32_16x16x32_bf16 v[132:135], a[236:239], a[212:215], v[132:135]
    ds_read_b128 a[176:179], v11 offset:18432
    v_mfma_f32_16x16x32_bf16 v[136:139], a[236:239], a[216:219], v[136:139]
    ds_read_b128 a[180:183], v11 offset:20480
    v_mfma_f32_16x16x32_bf16 v[116:119], a[232:235], a[216:219], v[116:119]
    ds_read_b128 a[184:187], v11 offset:22528
    v_mfma_f32_16x16x32_bf16 v[96:99], a[228:231], a[216:219], v[96:99]
    buffer_store_dwordx4 v[152:155], v176, s[4:7], s94 offen sc1
    v_mfma_f32_16x16x32_bf16 v[76:79], a[224:227], a[216:219], v[76:79]
    buffer_store_dwordx4 v[156:159], v176, s[4:7], s95 offen sc1
    v_mfma_f32_16x16x32_bf16 v[80:83], a[224:227], a[220:223], v[80:83]
    s_add_u32 m0, s43, 65536
    v_mfma_f32_16x16x32_bf16 v[100:103], a[228:231], a[220:223], v[100:103]
    buffer_load_dwordx4 v7, s[4:7], s41 offen offset:0 sc1 lds
    v_mfma_f32_16x16x32_bf16 v[120:123], a[232:235], a[220:223], v[120:123]
    s_add_u32 m0, s43, 65536
    v_mfma_f32_16x16x32_bf16 v[140:143], a[236:239], a[220:223], v[140:143]
    s_waitcnt lgkmcnt(0)
    v_mfma_f32_16x16x32_bf16 v[64:67], a[188:191], a[168:171], v[64:67]
    ds_read_b128 a[236:239], v239 offset:16384
    v_mfma_f32_16x16x32_bf16 v[84:87], a[192:195], a[168:171], v[84:87]
    ds_read_b128 a[208:211], v12 offset:16384
    v_mfma_f32_16x16x32_bf16 v[104:107], a[196:199], a[168:171], v[104:107]
    ds_read_b128 a[232:235], v238 offset:16384
    v_mfma_f32_16x16x32_bf16 v[124:127], a[200:203], a[168:171], v[124:127]
    buffer_load_dwordx4 v8, s[4:7], s41 offen offset:1024 sc1 lds
    v_mfma_f32_16x16x32_bf16 v[128:131], a[200:203], a[172:175], v[128:131]
    s_add_u32 m0, s43, 65536
    ds_read_b128 a[228:231], v237 offset:16384
    v_mfma_f32_16x16x32_bf16 v[108:111], a[196:199], a[172:175], v[108:111]
    ds_read_b128 a[224:227], v236 offset:16384
    v_mfma_f32_16x16x32_bf16 v[88:91], a[192:195], a[172:175], v[88:91]
    buffer_load_dwordx4 v9, s[4:7], s41 offen offset:2048 sc1 lds
    v_mfma_f32_16x16x32_bf16 v[68:71], a[188:191], a[172:175], v[68:71]
    ds_read_b128 a[212:215], v12 offset:18432
    v_mfma_f32_16x16x32_bf16 v[72:75], a[188:191], a[176:179], v[72:75]
    ds_read_b128 a[216:219], v12 offset:20480
    v_mfma_f32_16x16x32_bf16 v[92:95], a[192:195], a[176:179], v[92:95]
    ds_read_b128 a[220:223], v12 offset:22528
    v_mfma_f32_16x16x32_bf16 v[112:115], a[196:199], a[176:179], v[112:115]
    buffer_store_dwordx4 v[160:163], v176, s[4:7], s96 offen sc1
    v_mfma_f32_16x16x32_bf16 v[132:135], a[200:203], a[176:179], v[132:135]
    s_add_u32 m0, s43, 65536
    v_mfma_f32_16x16x32_bf16 v[136:139], a[200:203], a[180:183], v[136:139]
    buffer_load_dwordx4 v10, s[4:7], s41 offen offset:3072 sc1 lds
    v_mfma_f32_16x16x32_bf16 v[116:119], a[196:199], a[180:183], v[116:119]
    s_add_u32 s41, s41, 245760
    v_mfma_f32_16x16x32_bf16 v[96:99], a[192:195], a[180:183], v[96:99]
    buffer_store_dwordx4 v[164:167], v176, s[4:7], s97 offen sc1
    v_mfma_f32_16x16x32_bf16 v[76:79], a[188:191], a[180:183], v[76:79]
    v_mfma_f32_16x16x32_bf16 v[80:83], a[188:191], a[184:187], v[80:83]
    v_mfma_f32_16x16x32_bf16 v[100:103], a[192:195], a[184:187], v[100:103]
    buffer_store_dwordx4 v[168:171], v176, s[4:7], s98 offen sc1
    v_mfma_f32_16x16x32_bf16 v[120:123], a[196:199], a[184:187], v[120:123]
    v_mfma_f32_16x16x32_bf16 v[140:143], a[200:203], a[184:187], v[140:143]
    s_waitcnt lgkmcnt(0)
    v_mfma_f32_16x16x32_bf16 v[128:131], a[236:239], a[208:211], v[128:131]
    s_waitcnt vmcnt(11)
    s_barrier
    v_mfma_f32_16x16x32_bf16 v[108:111], a[232:235], a[208:211], v[108:111]
    ds_read_b128 a[188:191], v232 offset:32768
    v_mfma_f32_16x16x32_bf16 v[88:91], a[228:231], a[208:211], v[88:91]
    ds_read_b128 a[168:171], v13 offset:4096
    v_mfma_f32_16x16x32_bf16 v[68:71], a[224:227], a[208:211], v[68:71]
    ds_read_b128 a[192:195], v233 offset:32768
    v_mfma_f32_16x16x32_bf16 v[72:75], a[224:227], a[212:215], v[72:75]
    ds_read_b128 a[196:199], v234 offset:32768
    v_mfma_f32_16x16x32_bf16 v[92:95], a[228:231], a[212:215], v[92:95]
    ds_read_b128 a[200:203], v235 offset:32768
    v_mfma_f32_16x16x32_bf16 v[112:115], a[232:235], a[212:215], v[112:115]
    ds_read_b128 a[172:175], v11 offset:32768
    v_mfma_f32_16x16x32_bf16 v[132:135], a[236:239], a[212:215], v[132:135]
    ds_read_b128 a[176:179], v11 offset:34816
    v_mfma_f32_16x16x32_bf16 v[136:139], a[236:239], a[216:219], v[136:139]
    ds_read_b128 a[180:183], v11 offset:36864
    v_mfma_f32_16x16x32_bf16 v[116:119], a[232:235], a[216:219], v[116:119]
    ds_read_b128 a[184:187], v11 offset:38912
    v_mfma_f32_16x16x32_bf16 v[96:99], a[228:231], a[216:219], v[96:99]
    buffer_store_dwordx4 v[172:175], v176, s[4:7], s99 offen sc1
    v_mfma_f32_16x16x32_bf16 v[76:79], a[224:227], a[216:219], v[76:79]
    s_add_u32 m0, s43, 81920
    s_nop 0
    buffer_load_dwordx4 v7, s[4:7], s41 offen offset:0 sc1 lds
    v_mfma_f32_16x16x32_bf16 v[80:83], a[224:227], a[220:223], v[80:83]
    s_add_u32 m0, s43, 81920
    s_nop 0
    buffer_load_dwordx4 v8, s[4:7], s41 offen offset:1024 sc1 lds
    v_mfma_f32_16x16x32_bf16 v[100:103], a[228:231], a[220:223], v[100:103]
    s_add_u32 m0, s43, 81920
    v_mfma_f32_16x16x32_bf16 v[120:123], a[232:235], a[220:223], v[120:123]
    buffer_load_dwordx4 v9, s[4:7], s41 offen offset:2048 sc1 lds
    v_mfma_f32_16x16x32_bf16 v[140:143], a[236:239], a[220:223], v[140:143]
    s_waitcnt lgkmcnt(0)
    s_add_u32 m0, s43, 81920
    v_mfma_f32_16x16x32_bf16 v[64:67], a[188:191], a[168:171], v[64:67]
    ds_read_b128 a[236:239], v239 offset:32768
    v_mfma_f32_16x16x32_bf16 v[84:87], a[192:195], a[168:171], v[84:87]
    ds_read_b128 a[208:211], v12 offset:32768
    v_mfma_f32_16x16x32_bf16 v[104:107], a[196:199], a[168:171], v[104:107]
    ds_read_b128 a[232:235], v238 offset:32768
    v_mfma_f32_16x16x32_bf16 v[124:127], a[200:203], a[168:171], v[124:127]
    buffer_load_dwordx4 v10, s[4:7], s41 offen offset:3072 sc1 lds
    v_mfma_f32_16x16x32_bf16 v[128:131], a[200:203], a[172:175], v[128:131]
    s_add_u32 s41, s41, 245760
    s_add_u32 m0, s43, 0
    ds_read_b128 a[228:231], v237 offset:32768
    v_mfma_f32_16x16x32_bf16 v[108:111], a[196:199], a[172:175], v[108:111]
    ds_read_b128 a[224:227], v236 offset:32768
    v_mfma_f32_16x16x32_bf16 v[88:91], a[192:195], a[172:175], v[88:91]
    buffer_load_dwordx4 v4, s[16:19], s40 offen offset:0 lds
    v_mfma_f32_16x16x32_bf16 v[68:71], a[188:191], a[172:175], v[68:71]
    s_add_u32 m0, s43, 0
    ds_read_b128 a[212:215], v12 offset:34816
    v_mfma_f32_16x16x32_bf16 v[72:75], a[188:191], a[176:179], v[72:75]
    ds_read_b128 a[216:219], v12 offset:36864
    v_mfma_f32_16x16x32_bf16 v[92:95], a[192:195], a[176:179], v[92:95]
    ds_read_b128 a[220:223], v12 offset:38912
    v_mfma_f32_16x16x32_bf16 v[112:115], a[196:199], a[176:179], v[112:115]
    buffer_load_dwordx4 v5, s[16:19], s40 offen offset:1024 lds
    v_mfma_f32_16x16x32_bf16 v[132:135], a[200:203], a[176:179], v[132:135]
    s_add_u32 s40, s40, 128
    s_add_u32 m0, s43, 0
    v_mfma_f32_16x16x32_bf16 v[136:139], a[200:203], a[180:183], v[136:139]
    buffer_load_dwordx4 v4, s[16:19], s49 offen offset:2048 lds
    v_mfma_f32_16x16x32_bf16 v[116:119], a[196:199], a[180:183], v[116:119]
    s_add_u32 m0, s43, 0
    v_mfma_f32_16x16x32_bf16 v[96:99], a[192:195], a[180:183], v[96:99]
    buffer_load_dwordx4 v5, s[16:19], s49 offen offset:3072 lds
    v_mfma_f32_16x16x32_bf16 v[76:79], a[188:191], a[180:183], v[76:79]
L_hop0:
    s_cbranch_execz L_hop4
    s_add_u32 s49, s49, 128
    s_add_u32 m0, s43, 16384
    v_mfma_f32_16x16x32_bf16 v[80:83], a[188:191], a[184:187], v[80:83]
    v_mfma_f32_16x16x32_bf16 v[100:103], a[192:195], a[184:187], v[100:103]
    buffer_load_dwordx4 v4, s[16:19], s40 offen offset:0 lds
    v_mfma_f32_16x16x32_bf16 v[120:123], a[196:199], a[184:187], v[120:123]
    v_mfma_f32_16x16x32_bf16 v[140:143], a[200:203], a[184:187], v[140:143]
    s_waitcnt lgkmcnt(0)
    s_add_u32 m0, s43, 16384
    v_mfma_f32_16x16x32_bf16 v[128:131], a[236:239], a[208:211], v[128:131]
    s_waitcnt vmcnt(9)
    s_barrier
    v_mfma_f32_16x16x32_bf16 v[108:111], a[232:235], a[208:211], v[108:111]
    ds_read_b128 a[188:191], v232 offset:0
    v_mfma_f32_16x16x32_bf16 v[88:91], a[228:231], a[208:211], v[88:91]
    ds_read_b128 a[168:171], v13 offset:6144
    v_mfma_f32_16x16x32_bf16 v[68:71], a[224:227], a[208:211], v[68:71]
    ds_read_b128 a[192:195], v233 offset:0
    v_mfma_f32_16x16x32_bf16 v[72:75], a[224:227], a[212:215], v[72:75]
    ds_read_b128 a[196:199], v234 offset:0
    v_mfma_f32_16x16x32_bf16 v[92:95], a[228:231], a[212:215], v[92:95]
    ds_read_b128 a[200:203], v235 offset:0
    v_mfma_f32_16x16x32_bf16 v[112:115], a[232:235], a[212:215], v[112:115]
    ds_read_b128 a[172:175], v11 offset:49152
    v_mfma_f32_16x16x32_bf16 v[132:135], a[236:239], a[212:215], v[132:135]
    ds_read_b128 a[176:179], v11 offset:51200
    v_mfma_f32_16x16x32_bf16 v[136:139], a[236:239], a[216:219], v[136:139]
    ds_read_b128 a[180:183], v11 offset:53248
    v_mfma_f32_16x16x32_bf16 v[116:119], a[232:235], a[216:219], v[116:119]
    ds_read_b128 a[184:187], v11 offset:55296
    v_mfma_f32_16x16x32_bf16 v[96:99], a[228:231], a[216:219], v[96:99]
    buffer_store_dword v55, v52, s[4:7], 0 offen sc1
    v_mfma_f32_16x16x32_bf16 v[76:79], a[224:227], a[216:219], v[76:79]
    buffer_load_dwordx4 v5, s[16:19], s40 offen offset:1024 lds
    v_mfma_f32_16x16x32_bf16 v[80:83], a[224:227], a[220:223], v[80:83]
    s_add_u32 s40, s40, 128
    s_add_u32 m0, s43, 98304
    v_mfma_f32_16x16x32_bf16 v[100:103], a[228:231], a[220:223], v[100:103]
    buffer_load_dwordx4 v7, s[4:7], s41 offen offset:0 sc1 lds
    v_mfma_f32_16x16x32_bf16 v[120:123], a[232:235], a[220:223], v[120:123]
    s_add_u32 m0, s43, 98304
    s_nop 0
    buffer_load_dwordx4 v8, s[4:7], s41 offen offset:1024 sc1 lds
    v_mfma_f32_16x16x32_bf16 v[140:143], a[236:239], a[220:223], v[140:143]
    s_waitcnt lgkmcnt(0)
    s_add_u32 m0, s43, 98304
    v_mfma_f32_16x16x32_bf16 v[64:67], a[188:191], a[168:171], v[64:67]
    ds_read_b128 a[236:239], v239 offset:0
    v_mfma_f32_16x16x32_bf16 v[84:87], a[192:195], a[168:171], v[84:87]
    ds_read_b128 a[208:211], v12 offset:49152
    v_mfma_f32_16x16x32_bf16 v[104:107], a[196:199], a[168:171], v[104:107]
    ds_read_b128 a[232:235], v238 offset:0
    v_mfma_f32_16x16x32_bf16 v[124:127], a[200:203], a[168:171], v[124:127]
    buffer_load_dwordx4 v9, s[4:7], s41 offen offset:2048 sc1 lds
    v_mfma_f32_16x16x32_bf16 v[128:131], a[200:203], a[172:175], v[128:131]
    s_add_u32 m0, s43, 98304
    ds_read_b128 a[228:231], v237 offset:0
    v_mfma_f32_16x16x32_bf16 v[108:111], a[196:199], a[172:175], v[108:111]
    ds_read_b128 a[224:227], v236 offset:0
    v_mfma_f32_16x16x32_bf16 v[88:91], a[192:195], a[172:175], v[88:91]
    buffer_load_dwordx4 v10, s[4:7], s41 offen offset:3072 sc1 lds
    v_mfma_f32_16x16x32_bf16 v[68:71], a[188:191], a[172:175], v[68:71]
    s_add_u32 s41, s41, 245760
    s_add_u32 m0, s43, 16384
    ds_read_b128 a[212:215], v12 offset:51200
    v_mfma_f32_16x16x32_bf16 v[72:75], a[188:191], a[176:179], v[72:75]
    ds_read_b128 a[216:219], v12 offset:53248
    v_mfma_f32_16x16x32_bf16 v[92:95], a[192:195], a[176:179], v[92:95]
    ds_read_b128 a[220:223], v12 offset:55296
    v_mfma_f32_16x16x32_bf16 v[112:115], a[196:199], a[176:179], v[112:115]
    buffer_load_dwordx4 v4, s[16:19], s49 offen offset:2048 lds
    v_mfma_f32_16x16x32_bf16 v[132:135], a[200:203], a[176:179], v[132:135]
    s_add_u32 m0, s43, 16384
    s_nop 0
    buffer_load_dwordx4 v5, s[16:19], s49 offen offset:3072 lds
    v_mfma_f32_16x16x32_bf16 v[136:139], a[200:203], a[180:183], v[136:139]
    s_add_u32 s49, s49, 128
    s_add_u32 m0, s43, 32768
    v_mfma_f32_16x16x32_bf16 v[116:119], a[196:199], a[180:183], v[116:119]
    buffer_load_dwordx4 v4, s[16:19], s40 offen offset:0 lds
    v_mfma_f32_16x16x32_bf16 v[96:99], a[192:195], a[180:183], v[96:99]
    s_add_u32 m0, s43, 32768
    v_mfma_f32_16x16x32_bf16 v[76:79], a[188:191], a[180:183], v[76:79]
    buffer_load_dwordx4 v5, s[16:19], s40 offen offset:1024 lds
    v_mfma_f32_16x16x32_bf16 v[80:83], a[188:191], a[184:187], v[80:83]
    s_add_u32 s40, s40, 128
    s_add_u32 m0, s43, 32768
    v_mfma_f32_16x16x32_bf16 v[100:103], a[192:195], a[184:187], v[100:103]
    buffer_load_dwordx4 v4, s[16:19], s49 offen offset:2048 lds
    v_mfma_f32_16x16x32_bf16 v[120:123], a[196:199], a[184:187], v[120:123]
    s_add_u32 m0, s43, 32768
    v_mfma_f32_16x16x32_bf16 v[140:143], a[200:203], a[184:187], v[140:143]
    s_waitcnt lgkmcnt(0)
    v_mfma_f32_16x16x32_bf16 v[128:131], a[236:239], a[208:211], v[128:131]
    s_waitcnt vmcnt(12)
    s_barrier
    v_mfma_f32_16x16x32_bf16 v[108:111], a[232:235], a[208:211], v[108:111]
    ds_read_b128 a[188:191], v232 offset:16384
    v_mfma_f32_16x16x32_bf16 v[88:91], a[228:231], a[208:211], v[88:91]
    ds_read_b128 a[168:171], v13 offset:8192
    v_mfma_f32_16x16x32_bf16 v[68:71], a[224:227], a[208:211], v[68:71]
    ds_read_b128 a[192:195], v233 offset:16384
    v_mfma_f32_16x16x32_bf16 v[72:75], a[224:227], a[212:215], v[72:75]
    ds_read_b128 a[196:199], v234 offset:16384
    v_mfma_f32_16x16x32_bf16 v[92:95], a[228:231], a[212:215], v[92:95]
    ds_read_b128 a[200:203], v235 offset:16384
    v_mfma_f32_16x16x32_bf16 v[112:115], a[232:235], a[212:215], v[112:115]
    ds_read_b128 a[172:175], v11 offset:0
    v_mfma_f32_16x16x32_bf16 v[132:135], a[236:239], a[212:215], v[132:135]
    ds_read_b128 a[176:179], v11 offset:2048
    v_mfma_f32_16x16x32_bf16 v[136:139], a[236:239], a[216:219], v[136:139]
    ds_read_b128 a[180:183], v11 offset:4096
    v_mfma_f32_16x16x32_bf16 v[116:119], a[232:235], a[216:219], v[116:119]
    ds_read_b128 a[184:187], v11 offset:6144
    v_mfma_f32_16x16x32_bf16 v[96:99], a[228:231], a[216:219], v[96:99]
    buffer_load_dwordx4 v5, s[16:19], s49 offen offset:3072 lds
    v_mfma_f32_16x16x32_bf16 v[76:79], a[224:227], a[216:219], v[76:79]
    s_add_u32 s49, s49, 128
    s_add_u32 m0, s43, 65536
    v_mfma_f32_16x16x32_bf16 v[80:83], a[224:227], a[220:223], v[80:83]
    buffer_load_dwordx4 v7, s[4:7], s41 offen offset:0 sc1 lds
    v_mfma_f32_16x16x32_bf16 v[100:103], a[228:231], a[220:223], v[100:103]
    s_add_u32 m0, s43, 65536
    s_nop 0
    buffer_load_dwordx4 v8, s[4:7], s41 offen offset:1024 sc1 lds
    v_mfma_f32_16x16x32_bf16 v[120:123], a[232:235], a[220:223], v[120:123]
    s_add_u32 m0, s43, 65536
    s_nop 0
    buffer_load_dwordx4 v9, s[4:7], s41 offen offset:2048 sc1 lds
    v_mfma_f32_16x16x32_bf16 v[140:143], a[236:239], a[220:223], v[140:143]
    s_waitcnt lgkmcnt(0)
    s_add_u32 m0, s43, 65536
    v_mfma_f32_16x16x32_bf16 v[64:67], a[188:191], a[168:171], v[64:67]
    ds_read_b128 a[236:239], v239 offset:16384
    v_mfma_f32_16x16x32_bf16 v[84:87], a[192:195], a[168:171], v[84:87]
    ds_read_b128 a[208:211], v12 offset:0
    v_mfma_f32_16x16x32_bf16 v[104:107], a[196:199], a[168:171], v[104:107]
    ds_read_b128 a[232:235], v238 offset:16384
    v_mfma_f32_16x16x32_bf16 v[124:127], a[200:203], a[168:171], v[124:127]
    buffer_load_dwordx4 v10, s[4:7], s41 offen offset:3072 sc1 lds
    v_mfma_f32_16x16x32_bf16 v[128:131], a[200:203], a[172:175], v[128:131]
    s_add_u32 s41, s41, 245760
    s_add_u32 m0, s43, 49152
    ds_read_b128 a[228:231], v237 offset:16384
    v_mfma_f32_16x16x32_bf16 v[108:111], a[196:199], a[172:175], v[108:111]
    ds_read_b128 a[224:227], v236 offset:16384
    v_mfma_f32_16x16x32_bf16 v[88:91], a[192:195], a[172:175], v[88:91]
    buffer_load_dwordx4 v4, s[16:19], s40 offen offset:0 lds
    v_mfma_f32_16x16x32_bf16 v[68:71], a[188:191], a[172:175], v[68:71]
    s_add_u32 m0, s43, 49152
    ds_read_b128 a[212:215], v12 offset:2048
    v_mfma_f32_16x16x32_bf16 v[72:75], a[188:191], a[176:179], v[72:75]
    ds_read_b128 a[216:219], v12 offset:4096
    v_mfma_f32_16x16x32_bf16 v[92:95], a[192:195], a[176:179], v[92:95]
    ds_read_b128 a[220:223], v12 offset:6144
    v_mfma_f32_16x16x32_bf16 v[112:115], a[196:199], a[176:179], v[112:115]
    buffer_load_dwordx4 v5, s[16:19], s40 offen offset:1024 lds
    v_mfma_f32_16x16x32_bf16 v[132:135], a[200:203], a[176:179], v[132:135]
    s_add_u32 s40, s40, 128
    s_add_u32 m0, s43, 49152
    v_mfma_f32_16x16x32_bf16 v[136:139], a[200:203], a[180:183], v[136:139]
    buffer_load_dwordx4 v4, s[16:19], s49 offen offset:2048 lds
    v_mfma_f32_16x16x32_bf16 v[116:119], a[196:199], a[180:183], v[116:119]
    s_add_u32 m0, s43, 49152
    v_mfma_f32_16x16x32_bf16 v[96:99], a[192:195], a[180:183], v[96:99]
    buffer_load_dwordx4 v5, s[16:19], s49 offen offset:3072 lds
    v_mfma_f32_16x16x32_bf16 v[76:79], a[188:191], a[180:183], v[76:79]
    s_add_u32 s49, s49, 128
    v_mfma_f32_16x16x32_bf16 v[80:83], a[188:191], a[184:187], v[80:83]
    v_mfma_f32_16x16x32_bf16 v[100:103], a[192:195], a[184:187], v[100:103]
    v_mfma_f32_16x16x32_bf16 v[120:123], a[196:199], a[184:187], v[120:123]
    v_mfma_f32_16x16x32_bf16 v[140:143], a[200:203], a[184:187], v[140:143]
    s_waitcnt lgkmcnt(0)
    v_mfma_f32_16x16x32_bf16 v[128:131], a[236:239], a[208:211], v[128:131]
    s_waitcnt vmcnt(12)
    s_barrier
    v_mfma_f32_16x16x32_bf16 v[108:111], a[232:235], a[208:211], v[108:111]
    s_add_u32 m0, s43, 81920
    ds_read_b128 a[188:191], v232 offset:32768
    v_mfma_f32_16x16x32_bf16 v[88:91], a[228:231], a[208:211], v[88:91]
    ds_read_b128 a[168:171], v13 offset:10240
    v_mfma_f32_16x16x32_bf16 v[68:71], a[224:227], a[208:211], v[68:71]
    ds_read_b128 a[192:195], v233 offset:32768
    v_mfma_f32_16x16x32_bf16 v[72:75], a[224:227], a[212:215], v[72:75]
    ds_read_b128 a[196:199], v234 offset:32768
    v_mfma_f32_16x16x32_bf16 v[92:95], a[228:231], a[212:215], v[92:95]
    ds_read_b128 a[200:203], v235 offset:32768
    v_mfma_f32_16x16x32_bf16 v[112:115], a[232:235], a[212:215], v[112:115]
    ds_read_b128 a[172:175], v11 offset:16384
    v_mfma_f32_16x16x32_bf16 v[132:135], a[236:239], a[212:215], v[132:135]
    ds_read_b128 a[176:179], v11 offset:18432
    v_mfma_f32_16x16x32_bf16 v[136:139], a[236:239], a[216:219], v[136:139]
    ds_read_b128 a[180:183], v11 offset:20480
    v_mfma_f32_16x16x32_bf16 v[116:119], a[232:235], a[216:219], v[116:119]
    ds_read_b128 a[184:187], v11 offset:22528
    v_mfma_f32_16x16x32_bf16 v[96:99], a[228:231], a[216:219], v[96:99]
    buffer_load_dwordx4 v7, s[4:7], s41 offen offset:0 sc1 lds
    v_mfma_f32_16x16x32_bf16 v[76:79], a[224:227], a[216:219], v[76:79]
    s_add_u32 m0, s43, 81920
    s_nop 0
    buffer_load_dwordx4 v8, s[4:7], s41 offen offset:1024 sc1 lds
    v_mfma_f32_16x16x32_bf16 v[80:83], a[224:227], a[220:223], v[80:83]
    s_add_u32 m0, s43, 81920
    s_nop 0
    buffer_load_dwordx4 v9, s[4:7], s41 offen offset:2048 sc1 lds
    v_mfma_f32_16x16x32_bf16 v[100:103], a[228:231], a[220:223], v[100:103]
    s_add_u32 m0, s43, 81920
    v_mfma_f32_16x16x32_bf16 v[120:123], a[232:235], a[220:223], v[120:123]
    buffer_load_dwordx4 v10, s[4:7], s41 offen offset:3072 sc1 lds
    v_mfma_f32_16x16x32_bf16 v[140:143], a[236:239], a[220:223], v[140:143]
    s_waitcnt lgkmcnt(0)
    s_add_u32 s41, s41, 245760
    s_add_u32 m0, s43, 0
    v_mfma_f32_16x16x32_bf16 v[64:67], a[188:191], a[168:171], v[64:67]
    ds_read_b128 a[236:239], v239 offset:32768
    v_mfma_f32_16x16x32_bf16 v[84:87], a[192:195], a[168:171], v[84:87]
    ds_read_b128 a[208:211], v12 offset:16384
    v_mfma_f32_16x16x32_bf16 v[104:107], a[196:199], a[168:171], v[104:107]
    ds_read_b128 a[232:235], v238 offset:32768
    v_mfma_f32_16x16x32_bf16 v[124:127], a[200:203], a[168:171], v[124:127]
    buffer_load_dwordx4 v4, s[16:19], s40 offen offset:0 lds
    v_mfma_f32_16x16x32_bf16 v[128:131], a[200:203], a[172:175], v[128:131]
    s_add_u32 m0, s43, 0
    ds_read_b128 a[228:231], v237 offset:32768
    v_mfma_f32_16x16x32_bf16 v[108:111], a[196:199], a[172:175], v[108:111]
    ds_read_b128 a[224:227], v236 offset:32768
    v_mfma_f32_16x16x32_bf16 v[88:91], a[192:195], a[172:175], v[88:91]
    buffer_load_dwordx4 v5, s[16:19], s40 offen offset:1024 lds
    v_mfma_f32_16x16x32_bf16 v[68:71], a[188:191], a[172:175], v[68:71]
    s_add_u32 s40, s40, 128
    s_add_u32 m0, s43, 0
    ds_read_b128 a[212:215], v12 offset:18432
    v_mfma_f32_16x16x32_bf16 v[72:75], a[188:191], a[176:179], v[72:75]
    ds_read_b128 a[216:219], v12 offset:20480
    v_mfma_f32_16x16x32_bf16 v[92:95], a[192:195], a[176:179], v[92:95]
    ds_read_b128 a[220:223], v12 offset:22528
    v_mfma_f32_16x16x32_bf16 v[112:115], a[196:199], a[176:179], v[112:115]
    buffer_load_dwordx4 v4, s[16:19], s49 offen offset:2048 lds
    v_mfma_f32_16x16x32_bf16 v[132:135], a[200:203], a[176:179], v[132:135]
    s_add_u32 m0, s43, 0
    v_mfma_f32_16x16x32_bf16 v[136:139], a[200:203], a[180:183], v[136:139]
    buffer_load_dwordx4 v5, s[16:19], s49 offen offset:3072 lds
    v_mfma_f32_16x16x32_bf16 v[116:119], a[196:199], a[180:183], v[116:119]
    s_add_u32 s49, s49, 128
    v_mfma_f32_16x16x32_bf16 v[96:99], a[192:195], a[180:183], v[96:99]
    v_mfma_f32_16x16x32_bf16 v[76:79], a[188:191], a[180:183], v[76:79]
    v_mfma_f32_16x16x32_bf16 v[80:83], a[188:191], a[184:187], v[80:83]
    v_mfma_f32_16x16x32_bf16 v[100:103], a[192:195], a[184:187], v[100:103]
    v_mfma_f32_16x16x32_bf16 v[120:123], a[196:199], a[184:187], v[120:123]
    v_mfma_f32_16x16x32_bf16 v[140:143], a[200:203], a[184:187], v[140:143]
    s_waitcnt lgkmcnt(0)
    v_mfma_f32_16x16x32_bf16 v[128:131], a[236:239], a[208:211], v[128:131]
    s_waitcnt vmcnt(12)
    s_barrier
    v_mfma_f32_16x16x32_bf16 v[108:111], a[232:235], a[208:211], v[108:111]
    s_add_u32 m0, s43, 98304
    ds_read_b128 a[188:191], v232 offset:0
    v_mfma_f32_16x16x32_bf16 v[88:91], a[228:231], a[208:211], v[88:91]
    ds_read_b128 a[168:171], v13 offset:12288
    v_mfma_f32_16x16x32_bf16 v[68:71], a[224:227], a[208:211], v[68:71]
    ds_read_b128 a[192:195], v233 offset:0
    v_mfma_f32_16x16x32_bf16 v[72:75], a[224:227], a[212:215], v[72:75]
    ds_read_b128 a[196:199], v234 offset:0
    v_mfma_f32_16x16x32_bf16 v[92:95], a[228:231], a[212:215], v[92:95]
    ds_read_b128 a[200:203], v235 offset:0
    v_mfma_f32_16x16x32_bf16 v[112:115], a[232:235], a[212:215], v[112:115]
    ds_read_b128 a[172:175], v11 offset:32768
    v_mfma_f32_16x16x32_bf16 v[132:135], a[236:239], a[212:215], v[132:135]
    ds_read_b128 a[176:179], v11 offset:34816
    v_mfma_f32_16x16x32_bf16 v[136:139], a[236:239], a[216:219], v[136:139]
    ds_read_b128 a[180:183], v11 offset:36864
    v_mfma_f32_16x16x32_bf16 v[116:119], a[232:235], a[216:219], v[116:119]
    ds_read_b128 a[184:187], v11 offset:38912
    v_mfma_f32_16x16x32_bf16 v[96:99], a[228:231], a[216:219], v[96:99]
    buffer_load_dwordx4 v7, s[4:7], s41 offen offset:0 sc1 lds
    v_mfma_f32_16x16x32_bf16 v[76:79], a[224:227], a[216:219], v[76:79]
    s_add_u32 m0, s43, 98304
    s_nop 0
    buffer_load_dwordx4 v8, s[4:7], s41 offen offset:1024 sc1 lds
    v_mfma_f32_16x16x32_bf16 v[80:83], a[224:227], a[220:223], v[80:83]
    s_add_u32 m0, s43, 98304
    s_nop 0
    buffer_load_dwordx4 v9, s[4:7], s41 offen offset:2048 sc1 lds
    v_mfma_f32_16x16x32_bf16 v[100:103], a[228:231], a[220:223], v[100:103]
    s_add_u32 m0, s43, 98304
    v_mfma_f32_16x16x32_bf16 v[120:123], a[232:235], a[220:223], v[120:123]
    buffer_load_dwordx4 v10, s[4:7], s41 offen offset:3072 sc1 lds
    v_mfma_f32_16x16x32_bf16 v[140:143], a[236:239], a[220:223], v[140:143]
    s_waitcnt lgkmcnt(0)
    s_add_u32 s41, s41, 245760
    s_add_u32 m0, s43, 16384
    v_mfma_f32_16x16x32_bf16 v[64:67], a[188:191], a[168:171], v[64:67]
    ds_read_b128 a[236:239], v239 offset:0
    v_mfma_f32_16x16x32_bf16 v[84:87], a[192:195], a[168:171], v[84:87]
    ds_read_b128 a[208:211], v12 offset:32768
    v_mfma_f32_16x16x32_bf16 v[104:107], a[196:199], a[168:171], v[104:107]
    ds_read_b128 a[232:235], v238 offset:0
    v_mfma_f32_16x16x32_bf16 v[124:127], a[200:203], a[168:171], v[124:127]
    buffer_load_dwordx4 v4, s[16:19], s40 offen offset:0 lds
    v_mfma_f32_16x16x32_bf16 v[128:131], a[200:203], a[172:175], v[128:131]
    s_add_u32 m0, s43, 16384
    ds_read_b128 a[228:231], v237 offset:0
    v_mfma_f32_16x16x32_bf16 v[108:111], a[196:199], a[172:175], v[108:111]
    ds_read_b128 a[224:227], v236 offset:0
    v_mfma_f32_16x16x32_bf16 v[88:91], a[192:195], a[172:175], v[88:91]
    buffer_load_dwordx4 v5, s[16:19], s40 offen offset:1024 lds
    v_mfma_f32_16x16x32_bf16 v[68:71], a[188:191], a[172:175], v[68:71]
    s_add_u32 s40, s40, 128
    ds_read_b128 a[212:215], v12 offset:34816
    v_mfma_f32_16x16x32_bf16 v[72:75], a[188:191], a[176:179], v[72:75]
    ds_read_b128 a[216:219], v12 offset:36864
    v_mfma_f32_16x16x32_bf16 v[92:95], a[192:195], a[176:179], v[92:95]
    ds_read_b128 a[220:223], v12 offset:38912
    v_mfma_f32_16x16x32_bf16 v[112:115], a[196:199], a[176:179], v[112:115]
    buffer_load_dword v24, v56, s[4:7], s63 offen sc1
    v_mfma_f32_16x16x32_bf16 v[132:135], a[200:203], a[176:179], v[132:135]
    s_add_u32 m0, s43, 16384
    v_mfma_f32_16x16x32_bf16 v[136:139], a[200:203], a[180:183], v[136:139]
    buffer_load_dwordx4 v4, s[16:19], s49 offen offset:2048 lds
    v_mfma_f32_16x16x32_bf16 v[116:119], a[196:199], a[180:183], v[116:119]
    s_add_u32 m0, s43, 16384
    v_mfma_f32_16x16x32_bf16 v[96:99], a[192:195], a[180:183], v[96:99]
    buffer_load_dwordx4 v5, s[16:19], s49 offen offset:3072 lds
    v_mfma_f32_16x16x32_bf16 v[76:79], a[188:191], a[180:183], v[76:79]
    s_add_u32 s49, s49, 128
    v_mfma_f32_16x16x32_bf16 v[80:83], a[188:191], a[184:187], v[80:83]
    v_mfma_f32_16x16x32_bf16 v[100:103], a[192:195], a[184:187], v[100:103]
    v_mfma_f32_16x16x32_bf16 v[120:123], a[196:199], a[184:187], v[120:123]
    v_mfma_f32_16x16x32_bf16 v[140:143], a[200:203], a[184:187], v[140:143]
    s_waitcnt lgkmcnt(0)
    v_mfma_f32_16x16x32_bf16 v[128:131], a[236:239], a[208:211], v[128:131]
    s_waitcnt vmcnt(13)
    s_barrier
    v_mfma_f32_16x16x32_bf16 v[108:111], a[232:235], a[208:211], v[108:111]
    s_add_u32 m0, s43, 65536
    ds_read_b128 a[188:191], v232 offset:16384
    v_mfma_f32_16x16x32_bf16 v[88:91], a[228:231], a[208:211], v[88:91]
    ds_read_b128 a[168:171], v13 offset:14336
    v_mfma_f32_16x16x32_bf16 v[68:71], a[224:227], a[208:211], v[68:71]
    ds_read_b128 a[192:195], v233 offset:16384
    v_mfma_f32_16x16x32_bf16 v[72:75], a[224:227], a[212:215], v[72:75]
    ds_read_b128 a[196:199], v234 offset:16384
    v_mfma_f32_16x16x32_bf16 v[92:95], a[228:231], a[212:215], v[92:95]
    ds_read_b128 a[200:203], v235 offset:16384
    v_mfma_f32_16x16x32_bf16 v[112:115], a[232:235], a[212:215], v[112:115]
    ds_read_b128 a[172:175], v11 offset:49152
    v_mfma_f32_16x16x32_bf16 v[132:135], a[236:239], a[212:215], v[132:135]
    ds_read_b128 a[176:179], v11 offset:51200
    v_mfma_f32_16x16x32_bf16 v[136:139], a[236:239], a[216:219], v[136:139]
    ds_read_b128 a[180:183], v11 offset:53248
    v_mfma_f32_16x16x32_bf16 v[116:119], a[232:235], a[216:219], v[116:119]
    ds_read_b128 a[184:187], v11 offset:55296
    v_mfma_f32_16x16x32_bf16 v[96:99], a[228:231], a[216:219], v[96:99]
    buffer_load_dwordx4 v7, s[4:7], s41 offen offset:0 sc1 lds
    v_mfma_f32_16x16x32_bf16 v[76:79], a[224:227], a[216:219], v[76:79]
    s_add_u32 m0, s43, 65536
    s_nop 0
    buffer_load_dwordx4 v8, s[4:7], s41 offen offset:1024 sc1 lds
    v_mfma_f32_16x16x32_bf16 v[80:83], a[224:227], a[220:223], v[80:83]
    s_add_u32 m0, s43, 65536
    s_nop 0
    buffer_load_dwordx4 v9, s[4:7], s41 offen offset:2048 sc1 lds
    v_mfma_f32_16x16x32_bf16 v[100:103], a[228:231], a[220:223], v[100:103]
    s_add_u32 m0, s43, 65536
    v_mfma_f32_16x16x32_bf16 v[120:123], a[232:235], a[220:223], v[120:123]
    buffer_load_dwordx4 v10, s[4:7], s41 offen offset:3072 sc1 lds
    v_mfma_f32_16x16x32_bf16 v[140:143], a[236:239], a[220:223], v[140:143]
    s_waitcnt lgkmcnt(0)
    s_add_u32 s41, s41, 245760
    v_mfma_f32_16x16x32_bf16 v[64:67], a[188:191], a[168:171], v[64:67]
    ds_read_b128 a[236:239], v239 offset:16384
    v_mfma_f32_16x16x32_bf16 v[84:87], a[192:195], a[168:171], v[84:87]
    ds_read_b128 a[208:211], v12 offset:49152
    v_mfma_f32_16x16x32_bf16 v[104:107], a[196:199], a[168:171], v[104:107]
    ds_read_b128 a[232:235], v238 offset:16384
    v_mfma_f32_16x16x32_bf16 v[124:127], a[200:203], a[168:171], v[124:127]
    v_mfma_f32_16x16x32_bf16 v[128:131], a[200:203], a[172:175], v[128:131]
    ds_read_b128 a[228:231], v237 offset:16384
    v_mfma_f32_16x16x32_bf16 v[108:111], a[196:199], a[172:175], v[108:111]
    ds_read_b128 a[224:227], v236 offset:16384
    v_mfma_f32_16x16x32_bf16 v[88:91], a[192:195], a[172:175], v[88:91]
    v_mfma_f32_16x16x32_bf16 v[68:71], a[188:191], a[172:175], v[68:71]
    ds_read_b128 a[212:215], v12 offset:51200
    v_mfma_f32_16x16x32_bf16 v[72:75], a[188:191], a[176:179], v[72:75]
    ds_read_b128 a[216:219], v12 offset:53248
    v_mfma_f32_16x16x32_bf16 v[92:95], a[192:195], a[176:179], v[92:95]
    ds_read_b128 a[220:223], v12 offset:55296
    v_mfma_f32_16x16x32_bf16 v[112:115], a[196:199], a[176:179], v[112:115]
    v_mfma_f32_16x16x32_bf16 v[132:135], a[200:203], a[176:179], v[132:135]
    v_mfma_f32_16x16x32_bf16 v[136:139], a[200:203], a[180:183], v[136:139]
    v_mfma_f32_16x16x32_bf16 v[116:119], a[196:199], a[180:183], v[116:119]
    v_mfma_f32_16x16x32_bf16 v[96:99], a[192:195], a[180:183], v[96:99]
    v_mfma_f32_16x16x32_bf16 v[76:79], a[188:191], a[180:183], v[76:79]
    s_waitcnt vmcnt(6)
    v_cmp_ne_u32 vcc, s24, v24
    v_mfma_f32_16x16x32_bf16 v[80:83], a[188:191], a[184:187], v[80:83]
    v_mfma_f32_16x16x32_bf16 v[100:103], a[192:195], a[184:187], v[100:103]
    v_mfma_f32_16x16x32_bf16 v[120:123], a[196:199], a[184:187], v[120:123]
    s_cbranch_vccnz L_fb1
L_fbx1:
    v_mfma_f32_16x16x32_bf16 v[140:143], a[200:203], a[184:187], v[140:143]
    s_waitcnt lgkmcnt(0)
    v_mfma_f32_16x16x32_bf16 v[128:131], a[236:239], a[208:211], v[128:131]
    s_barrier
    v_mfma_f32_16x16x32_bf16 v[108:111], a[232:235], a[208:211], v[108:111]
    ds_read_b128 a[188:191], v232 offset:32768
    v_mfma_f32_16x16x32_bf16 v[88:91], a[228:231], a[208:211], v[88:91]
    ds_read_b128 a[168:171], v13 offset:16384
    v_mfma_f32_16x16x32_bf16 v[68:71], a[224:227], a[208:211], v[68:71]
    ds_read_b128 a[192:195], v233 offset:32768
    v_mfma_f32_16x16x32_bf16 v[72:75], a[224:227], a[212:215], v[72:75]
    ds_read_b128 a[196:199], v234 offset:32768
    v_mfma_f32_16x16x32_bf16 v[92:95], a[228:231], a[212:215], v[92:95]
    ds_read_b128 a[200:203], v235 offset:32768
    v_mfma_f32_16x16x32_bf16 v[112:115], a[232:235], a[212:215], v[112:115]
    ds_read_b128 a[172:175], v11 offset:0
    v_mfma_f32_16x16x32_bf16 v[132:135], a[236:239], a[212:215], v[132:135]
    ds_read_b128 a[176:179], v11 offset:2048
    v_mfma_f32_16x16x32_bf16 v[136:139], a[236:239], a[216:219], v[136:139]
    ds_read_b128 a[180:183], v11 offset:4096
    v_mfma_f32_16x16x32_bf16 v[116:119], a[232:235], a[216:219], v[116:119]
    ds_read_b128 a[184:187], v11 offset:6144
    v_mfma_f32_16x16x32_bf16 v[96:99], a[228:231], a[216:219], v[96:99]
    buffer_load_dwordx2 v[240:241], v21, s[4:7], s61 offen sc1
    v_mfma_f32_16x16x32_bf16 v[76:79], a[224:227], a[216:219], v[76:79]
    buffer_load_dwordx2 v[242:243], v21, s[4:7], s57 offen offset:0 sc1
    v_mfma_f32_16x16x32_bf16 v[80:83], a[224:227], a[220:223], v[80:83]
    buffer_load_dwordx2 v[244:245], v21, s[4:7], s57 offen offset:256 sc1
    v_mfma_f32_16x16x32_bf16 v[100:103], a[228:231], a[220:223], v[100:103]
    buffer_load_dwordx2 v[246:247], v21, s[4:7], s57 offen offset:512 sc1
    v_mfma_f32_16x16x32_bf16 v[120:123], a[232:235], a[220:223], v[120:123]
    buffer_load_dwordx2 v[248:249], v21, s[4:7], s57 offen offset:768 sc1
    v_mfma_f32_16x16x32_bf16 v[140:143], a[236:239], a[220:223], v[140:143]
    s_waitcnt lgkmcnt(0)
    s_add_u32 m0, s55, 36864
    v_mfma_f32_16x16x32_bf16 v[64:67], a[188:191], a[168:171], v[64:67]
    ds_read_b128 a[236:239], v239 offset:32768
    v_mfma_f32_16x16x32_bf16 v[84:87], a[192:195], a[168:171], v[84:87]
    ds_read_b128 a[208:211], v12 offset:0
    v_mfma_f32_16x16x32_bf16 v[104:107], a[196:199], a[168:171], v[104:107]
    ds_read_b128 a[232:235], v238 offset:32768
    v_mfma_f32_16x16x32_bf16 v[124:127], a[200:203], a[168:171], v[124:127]
    buffer_load_dwordx4 v61, s[4:7], s51 offen offset:0 sc1 lds
    v_mfma_f32_16x16x32_bf16 v[128:131], a[200:203], a[172:175], v[128:131]
    s_add_u32 m0, s55, 40704
    ds_read_b128 a[228:231], v237 offset:32768
    v_mfma_f32_16x16x32_bf16 v[108:111], a[196:199], a[172:175], v[108:111]
    ds_read_b128 a[224:227], v236 offset:32768
    v_mfma_f32_16x16x32_bf16 v[88:91], a[192:195], a[172:175], v[88:91]
    buffer_load_dwordx4 v61, s[4:7], s51 offen offset:256 sc1 lds
    v_mfma_f32_16x16x32_bf16 v[68:71], a[188:191], a[172:175], v[68:71]
    s_add_u32 m0, s55, 44544
    ds_read_b128 a[212:215], v12 offset:2048
    v_mfma_f32_16x16x32_bf16 v[72:75], a[188:191], a[176:179], v[72:75]
    ds_read_b128 a[216:219], v12 offset:4096
    v_mfma_f32_16x16x32_bf16 v[92:95], a[192:195], a[176:179], v[92:95]
    ds_read_b128 a[220:223], v12 offset:6144
    v_mfma_f32_16x16x32_bf16 v[112:115], a[196:199], a[176:179], v[112:115]
    buffer_load_dwordx4 v61, s[4:7], s51 offen offset:512 sc1 lds
    v_mfma_f32_16x16x32_bf16 v[132:135], a[200:203], a[176:179], v[132:135]
    s_add_u32 m0, s55, 32000
    s_nop 0
    buffer_load_dwordx4 v61, s[4:7], s51 offen offset:768 sc1 lds
    v_mfma_f32_16x16x32_bf16 v[136:139], a[200:203], a[180:183], v[136:139]
    s_add_u32 m0, s55, 52224
    v_mfma_f32_16x16x32_bf16 v[116:119], a[196:199], a[180:183], v[116:119]
    buffer_load_dwordx4 v61, s[4:7], s51 offen offset:1024 sc1 lds
    v_mfma_f32_16x16x32_bf16 v[96:99], a[192:195], a[180:183], v[96:99]
    s_add_u32 s51, s51, 40960
    s_add_u32 m0, s55, 57344
    v_mfma_f32_16x16x32_bf16 v[76:79], a[188:191], a[180:183], v[76:79]
    buffer_load_dwordx4 v61, s[4:7], s51 offen offset:0 sc1 lds
    v_mfma_f32_16x16x32_bf16 v[80:83], a[188:191], a[184:187], v[80:83]
    s_add_u32 m0, s55, 61184
    v_mfma_f32_16x16x32_bf16 v[100:103], a[192:195], a[184:187], v[100:103]
    buffer_load_dwordx4 v61, s[4:7], s51 offen offset:256 sc1 lds
    v_mfma_f32_16x16x32_bf16 v[120:123], a[196:199], a[184:187], v[120:123]
    v_mfma_f32_16x16x32_bf16 v[140:143], a[200:203], a[184:187], v[140:143]
    s_waitcnt lgkmcnt(0)
    s_add_u32 m0, s55, 48640
    v_mfma_f32_16x16x32_bf16 v[128:131], a[236:239], a[208:211], v[128:131]
    s_waitcnt vmcnt(12)
    s_barrier
    v_mfma_f32_16x16x32_bf16 v[108:111], a[232:235], a[208:211], v[108:111]
    ds_read_b128 a[188:191], v232 offset:0
    v_mfma_f32_16x16x32_bf16 v[88:91], a[228:231], a[208:211], v[88:91]
    ds_read_b128 a[168:171], v13 offset:18432
    v_mfma_f32_16x16x32_bf16 v[68:71], a[224:227], a[208:211], v[68:71]
    ds_read_b128 a[192:195], v233 offset:0
    v_mfma_f32_16x16x32_bf16 v[72:75], a[224:227], a[212:215], v[72:75]
    ds_read_b128 a[196:199], v234 offset:0
    v_mfma_f32_16x16x32_bf16 v[92:95], a[228:231], a[212:215], v[92:95]
    ds_read_b128 a[200:203], v235 offset:0
    v_mfma_f32_16x16x32_bf16 v[112:115], a[232:235], a[212:215], v[112:115]
    ds_read_b128 a[172:175], v11 offset:16384
    v_mfma_f32_16x16x32_bf16 v[132:135], a[236:239], a[212:215], v[132:135]
    ds_read_b128 a[176:179], v11 offset:18432
    v_mfma_f32_16x16x32_bf16 v[136:139], a[236:239], a[216:219], v[136:139]
    ds_read_b128 a[180:183], v11 offset:20480
    v_mfma_f32_16x16x32_bf16 v[116:119], a[232:235], a[216:219], v[116:119]
    ds_read_b128 a[184:187], v11 offset:22528
    v_mfma_f32_16x16x32_bf16 v[96:99], a[228:231], a[216:219], v[96:99]
    buffer_load_dwordx4 v61, s[4:7], s51 offen offset:512 sc1 lds
    v_mfma_f32_16x16x32_bf16 v[76:79], a[224:227], a[216:219], v[76:79]
    s_add_u32 m0, s55, 85248
    s_nop 0
    buffer_load_dwordx4 v61, s[4:7], s51 offen offset:768 sc1 lds
    v_mfma_f32_16x16x32_bf16 v[80:83], a[224:227], a[220:223], v[80:83]
    s_add_u32 m0, s55, 89088
    s_nop 0
    buffer_load_dwordx4 v61, s[4:7], s51 offen offset:1024 sc1 lds
    v_mfma_f32_16x16x32_bf16 v[100:103], a[228:231], a[220:223], v[100:103]
    s_add_u32 s51, s51, 40960
    s_add_u32 m0, s55, 94208
    v_mfma_f32_16x16x32_bf16 v[120:123], a[232:235], a[220:223], v[120:123]
    buffer_load_dwordx4 v61, s[4:7], s51 offen offset:0 sc1 lds
    v_mfma_f32_16x16x32_bf16 v[140:143], a[236:239], a[220:223], v[140:143]
    s_waitcnt lgkmcnt(0)
    s_add_u32 m0, s55, 81664
    v_mfma_f32_16x16x32_bf16 v[64:67], a[188:191], a[168:171], v[64:67]
    ds_read_b128 a[236:239], v239 offset:0
    v_mfma_f32_16x16x32_bf16 v[84:87], a[192:195], a[168:171], v[84:87]
    ds_read_b128 a[208:211], v12 offset:16384
    v_mfma_f32_16x16x32_bf16 v[104:107], a[196:199], a[168:171], v[104:107]
    ds_read_b128 a[232:235], v238 offset:0
    v_mfma_f32_16x16x32_bf16 v[124:127], a[200:203], a[168:171], v[124:127]
    buffer_load_dwordx4 v61, s[4:7], s51 offen offset:256 sc1 lds
    v_mfma_f32_16x16x32_bf16 v[128:131], a[200:203], a[172:175], v[128:131]
    s_add_u32 m0, s55, 3584
    ds_read_b128 a[228:231], v237 offset:0
    v_mfma_f32_16x16x32_bf16 v[108:111], a[196:199], a[172:175], v[108:111]
    ds_read_b128 a[224:227], v236 offset:0
    v_mfma_f32_16x16x32_bf16 v[88:91], a[192:195], a[172:175], v[88:91]
    buffer_load_dwordx4 v61, s[4:7], s51 offen offset:512 sc1 lds
    v_mfma_f32_16x16x32_bf16 v[68:71], a[188:191], a[172:175], v[68:71]
    s_add_u32 m0, s55, 7424
    ds_read_b128 a[212:215], v12 offset:18432
    v_mfma_f32_16x16x32_bf16 v[72:75], a[188:191], a[176:179], v[72:75]
L_hop1:
    s_cbranch_execz L_hop5
    ds_read_b128 a[216:219], v12 offset:20480
    v_mfma_f32_16x16x32_bf16 v[92:95], a[192:195], a[176:179], v[92:95]
    ds_read_b128 a[220:223], v12 offset:22528
    v_mfma_f32_16x16x32_bf16 v[112:115], a[196:199], a[176:179], v[112:115]
    ds_write_b128 v14, v[64:67] offset:0
    v_mfma_f32_16x16x32_bf16 v[132:135], a[200:203], a[176:179], v[132:135]
    ds_write_b128 v14, v[84:87] offset:1024
    v_mfma_f32_16x16x32_bf16 v[136:139], a[200:203], a[180:183], v[136:139]
    buffer_load_dwordx4 v61, s[4:7], s51 offen offset:768 sc1 lds
    v_mfma_f32_16x16x32_bf16 v[116:119], a[196:199], a[180:183], v[116:119]
    s_add_u32 m0, s55, 11264
    ds_write_b128 v14, v[104:107] offset:2048
    v_mfma_f32_16x16x32_bf16 v[96:99], a[192:195], a[180:183], v[96:99]
    buffer_load_dwordx4 v61, s[4:7], s51 offen offset:1024 sc1 lds
    v_mfma_f32_16x16x32_bf16 v[76:79], a[188:191], a[180:183], v[76:79]
    s_add_u32 s51, s51, 40960
    ds_write_b128 v14, v[124:127] offset:3072
    v_mfma_f32_16x16x32_bf16 v[80:83], a[188:191], a[184:187], v[80:83]
    s_add_u32 m0, s55, 0
    v_mfma_f32_16x16x32_bf16 v[100:103], a[192:195], a[184:187], v[100:103]
    buffer_load_dwordx4 v61, s[4:7], s51 offen offset:0 sc1 lds
    v_mfma_f32_16x16x32_bf16 v[120:123], a[196:199], a[184:187], v[120:123]
    s_add_u32 m0, s55, 102144
    v_mfma_f32_16x16x32_bf16 v[140:143], a[200:203], a[184:187], v[140:143]
    s_waitcnt lgkmcnt(4)
    v_mfma_f32_16x16x32_bf16 v[128:131], a[236:239], a[208:211], v[128:131]
    s_waitcnt lgkmcnt(0)
    s_barrier
    v_mfma_f32_16x16x32_bf16 v[108:111], a[232:235], a[208:211], v[108:111]
    ds_read_b128 v[210:213], v26 offset:0
    ds_read_b128 v[214:217], v26 offset:1024
    v_mfma_f32_16x16x32_bf16 v[88:91], a[228:231], a[208:211], v[88:91]
    ds_read_b128 v[218:221], v26 offset:2048
    ds_read_b128 v[222:225], v26 offset:3072
    v_mfma_f32_16x16x32_bf16 v[68:71], a[224:227], a[208:211], v[68:71]
    buffer_load_dwordx4 v61, s[4:7], s51 offen offset:256 sc1 lds
    v_mfma_f32_16x16x32_bf16 v[72:75], a[224:227], a[212:215], v[72:75]
    s_add_u32 m0, s55, 105984
    s_nop 0
    buffer_load_dwordx4 v61, s[4:7], s51 offen offset:512 sc1 lds
    v_mfma_f32_16x16x32_bf16 v[92:95], a[228:231], a[212:215], v[92:95]
    s_add_u32 m0, s55, 109824
    v_mfma_f32_16x16x32_bf16 v[112:115], a[232:235], a[212:215], v[112:115]
    buffer_load_dwordx4 v61, s[4:7], s51 offen offset:768 sc1 lds
    v_mfma_f32_16x16x32_bf16 v[132:135], a[236:239], a[212:215], v[132:135]
    s_add_u32 m0, s55, 97280
    v_mfma_f32_16x16x32_bf16 v[136:139], a[236:239], a[216:219], v[136:139]
    buffer_load_dwordx4 v61, s[4:7], s51 offen offset:1024 sc1 lds
    v_mfma_f32_16x16x32_bf16 v[116:119], a[232:235], a[216:219], v[116:119]
    s_add_u32 s51, s51, 40960
    s_waitcnt lgkmcnt(0)
    v_add_f32 v64, v64, v210
    v_mfma_f32_16x16x32_bf16 v[96:99], a[228:231], a[216:219], v[96:99]
    v_add_f32 v65, v65, v211
    v_add_f32 v66, v66, v212
    v_mfma_f32_16x16x32_bf16 v[76:79], a[224:227], a[216:219], v[76:79]
    v_add_f32 v67, v67, v213
    v_add_f32 v84, v84, v214
    v_add_f32 v85, v85, v215
    v_mfma_f32_16x16x32_bf16 v[80:83], a[224:227], a[220:223], v[80:83]
    v_add_f32 v86, v86, v216
    v_add_f32 v87, v87, v217
    v_add_f32 v104, v104, v218
    v_mfma_f32_16x16x32_bf16 v[100:103], a[228:231], a[220:223], v[100:103]
    v_add_f32 v105, v105, v219
    v_add_f32 v106, v106, v220
    v_add_f32 v107, v107, v221
    v_mfma_f32_16x16x32_bf16 v[120:123], a[232:235], a[220:223], v[120:123]
    v_add_f32 v124, v124, v222
    v_add_f32 v125, v125, v223
    v_add_f32 v126, v126, v224
    v_mfma_f32_16x16x32_bf16 v[140:143], a[236:239], a[220:223], v[140:143]
    v_add_f32 v127, v127, v225
    v_mov_b32_dpp v4, v64 row_newbcast:8 row_mask:0xf bank_mask:0xf
    v_mov_b32_dpp v5, v65 row_newbcast:8 row_mask:0xf bank_mask:0xf
    v_mov_b32_dpp v6, v66 row_newbcast:8 row_mask:0xf bank_mask:0xf
    v_mov_b32_dpp v7, v67 row_newbcast:8 row_mask:0xf bank_mask:0xf
    v_mov_b32_dpp v8, v84 row_newbcast:8 row_mask:0xf bank_mask:0xf
    v_mov_b32_dpp v9, v85 row_newbcast:8 row_mask:0xf bank_mask:0xf
    v_mov_b32_dpp v10, v86 row_newbcast:8 row_mask:0xf bank_mask:0xf
    v_mov_b32_dpp v11, v87 row_newbcast:8 row_mask:0xf bank_mask:0xf
    v_mov_b32_dpp v12, v104 row_newbcast:8 row_mask:0xf bank_mask:0xf
    v_mov_b32_dpp v13, v105 row_newbcast:8 row_mask:0xf bank_mask:0xf
    v_mov_b32_dpp v14, v106 row_newbcast:8 row_mask:0xf bank_mask:0xf
    v_mov_b32_dpp v15, v107 row_newbcast:8 row_mask:0xf bank_mask:0xf
    v_mov_b32_dpp v16, v124 row_newbcast:8 row_mask:0xf bank_mask:0xf
    v_mov_b32_dpp v17, v125 row_newbcast:8 row_mask:0xf bank_mask:0xf
    v_mov_b32_dpp v18, v126 row_newbcast:8 row_mask:0xf bank_mask:0xf
    v_mov_b32_dpp v19, v127 row_newbcast:8 row_mask:0xf bank_mask:0xf
    s_waitcnt vmcnt(24)
    v_pk_fma_f32 v[84:85], v[8:9], v[240:241], v[84:85] op_sel_hi:[1,0,1]
    v_pk_fma_f32 v[86:87], v[10:11], v[240:241], v[86:87] op_sel_hi:[1,0,1]
    v_pk_mul_f32 v[84:85], v[84:85], v[240:241] op_sel:[0,1] op_sel_hi:[1,1]
    v_pk_mul_f32 v[86:87], v[86:87], v[240:241] op_sel:[0,1] op_sel_hi:[1,1]
    v_pk_fma_f32 v[104:105], v[12:13], v[240:241], v[104:105] op_sel_hi:[1,0,1]
    buffer_load_dwordx4 a[0:3], v60, s[4:7], s50 offen offset:0 sc1
    v_pk_fma_f32 v[106:107], v[14:15], v[240:241], v[106:107] op_sel_hi:[1,0,1]
    v_pk_mul_f32 v[104:105], v[104:105], v[240:241] op_sel:[0,1] op_sel_hi:[1,1]
    v_pk_mul_f32 v[106:107], v[106:107], v[240:241] op_sel:[0,1] op_sel_hi:[1,1]
    v_pk_fma_f32 v[124:125], v[16:17], v[240:241], v[124:125] op_sel_hi:[1,0,1]
    v_pk_fma_f32 v[126:127], v[18:19], v[240:241], v[126:127] op_sel_hi:[1,0,1]
    v_pk_mul_f32 v[124:125], v[124:125], v[240:241] op_sel:[0,1] op_sel_hi:[1,1]
    v_pk_mul_f32 v[126:127], v[126:127], v[240:241] op_sel:[0,1] op_sel_hi:[1,1]
    v_cvt_pk_bf16_f32 v164, v104, v105
    v_cvt_pk_bf16_f32 v165, v106, v107
    v_cvt_pk_bf16_f32 v160, v84, v85
    v_cvt_pk_bf16_f32 v161, v86, v87
    v_cvt_pk_bf16_f32 v162, v124, v125
    buffer_load_dwordx4 a[4:7], v60, s[4:7], s50 offen offset:256 sc1
    v_cvt_pk_bf16_f32 v163, v126, v127
    ds_write_b128 v46, v[162:165] offset:0
    s_waitcnt vmcnt(25)
    v_pk_fma_f32 v[68:69], v[4:5], v[242:243], v[68:69] op_sel_hi:[1,0,1]
    v_pk_fma_f32 v[70:71], v[6:7], v[242:243], v[70:71] op_sel_hi:[1,0,1]
    v_pk_mul_f32 v[68:69], v[68:69], v[242:243] op_sel:[0,1] op_sel_hi:[1,1]
    v_pk_mul_f32 v[70:71], v[70:71], v[242:243] op_sel:[0,1] op_sel_hi:[1,1]
    v_pk_fma_f32 v[88:89], v[8:9], v[242:243], v[88:89] op_sel_hi:[1,0,1]
    v_pk_fma_f32 v[90:91], v[10:11], v[242:243], v[90:91] op_sel_hi:[1,0,1]
    v_pk_mul_f32 v[88:89], v[88:89], v[242:243] op_sel:[0,1] op_sel_hi:[1,1]
    v_pk_mul_f32 v[90:91], v[90:91], v[242:243] op_sel:[0,1] op_sel_hi:[1,1]
    v_pk_fma_f32 v[108:109], v[12:13], v[242:243], v[108:109] op_sel_hi:[1,0,1]
    v_pk_fma_f32 v[110:111], v[14:15], v[242:243], v[110:111] op_sel_hi:[1,0,1]
    buffer_load_dwordx4 a[8:11], v60, s[4:7], s50 offen offset:512 sc1
    s_add_u32 s50, s50, 196608
    v_pk_mul_f32 v[108:109], v[108:109], v[242:243] op_sel:[0,1] op_sel_hi:[1,1]
    v_pk_mul_f32 v[110:111], v[110:111], v[242:243] op_sel:[0,1] op_sel_hi:[1,1]
    v_pk_fma_f32 v[128:129], v[16:17], v[242:243], v[128:129] op_sel_hi:[1,0,1]
    v_pk_fma_f32 v[130:131], v[18:19], v[242:243], v[130:131] op_sel_hi:[1,0,1]
    v_pk_mul_f32 v[128:129], v[128:129], v[242:243] op_sel:[0,1] op_sel_hi:[1,1]
    v_pk_mul_f32 v[130:131], v[130:131], v[242:243] op_sel:[0,1] op_sel_hi:[1,1]
    v_cvt_pk_bf16_f32 v144, v68, v69
    v_cvt_pk_bf16_f32 v145, v70, v71
    v_cvt_pk_bf16_f32 v170, v108, v109
    v_cvt_pk_bf16_f32 v171, v110, v111
    v_cvt_pk_bf16_f32 v166, v88, v89
    v_cvt_pk_bf16_f32 v167, v90, v91
    buffer_load_dwordx4 a[12:15], v60, s[4:7], s50 offen offset:0 sc1
    v_cvt_pk_bf16_f32 v168, v128, v129
    v_cvt_pk_bf16_f32 v169, v130, v131
    v_and_b32 v146, v49, v170
    v_and_b32 v147, v49, v171
    ds_write_b128 v46, v[168:171] offset:1280
    s_waitcnt vmcnt(26)
    v_pk_fma_f32 v[72:73], v[4:5], v[244:245], v[72:73] op_sel_hi:[1,0,1]
    v_pk_fma_f32 v[74:75], v[6:7], v[244:245], v[74:75] op_sel_hi:[1,0,1]
    v_pk_mul_f32 v[72:73], v[72:73], v[244:245] op_sel:[0,1] op_sel_hi:[1,1]
    v_pk_mul_f32 v[74:75], v[74:75], v[244:245] op_sel:[0,1] op_sel_hi:[1,1]
    v_pk_fma_f32 v[92:93], v[8:9], v[244:245], v[92:93] op_sel_hi:[1,0,1]
    v_pk_fma_f32 v[94:95], v[10:11], v[244:245], v[94:95] op_sel_hi:[1,0,1]
    v_pk_mul_f32 v[92:93], v[92:93], v[244:245] op_sel:[0,1] op_sel_hi:[1,1]
    buffer_load_dwordx4 a[16:19], v60, s[4:7], s50 offen offset:256 sc1
    v_pk_mul_f32 v[94:95], v[94:95], v[244:245] op_sel:[0,1] op_sel_hi:[1,1]
    v_pk_fma_f32 v[112:113], v[12:13], v[244:245], v[112:113] op_sel_hi:[1,0,1]
    v_pk_fma_f32 v[114:115], v[14:15], v[244:245], v[114:115] op_sel_hi:[1,0,1]
    v_pk_mul_f32 v[112:113], v[112:113], v[244:245] op_sel:[0,1] op_sel_hi:[1,1]
    v_pk_mul_f32 v[114:115], v[114:115], v[244:245] op_sel:[0,1] op_sel_hi:[1,1]
    v_pk_fma_f32 v[132:133], v[16:17], v[244:245], v[132:133] op_sel_hi:[1,0,1]
    v_pk_fma_f32 v[134:135], v[18:19], v[244:245], v[134:135] op_sel_hi:[1,0,1]
    v_pk_mul_f32 v[132:133], v[132:133], v[244:245] op_sel:[0,1] op_sel_hi:[1,1]
    v_pk_mul_f32 v[134:135], v[134:135], v[244:245] op_sel:[0,1] op_sel_hi:[1,1]
    v_mfma_f32_16x16x32_bf16 v[210:213], v[166:169], v[144:147], v[28:31]
    v_cvt_pk_bf16_f32 v148, v72, v73
    v_cvt_pk_bf16_f32 v149, v74, v75
    buffer_load_dwordx4 a[20:23], v60, s[4:7], s50 offen offset:512 sc1
    s_add_u32 s50, s50, 196608
    v_mfma_f32_16x16x32_bf16 v[64:67], v[160:163], v[144:147], v[36:39]
    v_cvt_pk_bf16_f32 v176, v112, v113
    v_cvt_pk_bf16_f32 v177, v114, v115
    v_cvt_pk_bf16_f32 v172, v92, v93
    v_cvt_pk_bf16_f32 v173, v94, v95
    v_cvt_pk_bf16_f32 v174, v132, v133
    v_cvt_pk_bf16_f32 v175, v134, v135
    v_and_b32 v150, v49, v176
    v_and_b32 v151, v49, v177
    ds_write_b128 v46, v[174:177] offset:2560
    s_waitcnt vmcnt(27)
    v_pk_fma_f32 v[76:77], v[4:5], v[246:247], v[76:77] op_sel_hi:[1,0,1]
    v_pk_fma_f32 v[78:79], v[6:7], v[246:247], v[78:79] op_sel_hi:[1,0,1]
    v_pk_mul_f32 v[76:77], v[76:77], v[246:247] op_sel:[0,1] op_sel_hi:[1,1]
    buffer_load_dwordx4 a[24:27], v60, s[4:7], s50 offen offset:0 sc1
    v_pk_mul_f32 v[78:79], v[78:79], v[246:247] op_sel:[0,1] op_sel_hi:[1,1]
    v_pk_fma_f32 v[96:97], v[8:9], v[246:247], v[96:97] op_sel_hi:[1,0,1]
    v_pk_fma_f32 v[98:99], v[10:11], v[246:247], v[98:99] op_sel_hi:[1,0,1]
    v_pk_mul_f32 v[96:97], v[96:97], v[246:247] op_sel:[0,1] op_sel_hi:[1,1]
    v_pk_mul_f32 v[98:99], v[98:99], v[246:247] op_sel:[0,1] op_sel_hi:[1,1]
    v_pk_fma_f32 v[116:117], v[12:13], v[246:247], v[116:117] op_sel_hi:[1,0,1]
    v_pk_fma_f32 v[118:119], v[14:15], v[246:247], v[118:119] op_sel_hi:[1,0,1]
    v_pk_mul_f32 v[116:117], v[116:117], v[246:247] op_sel:[0,1] op_sel_hi:[1,1]
    v_pk_mul_f32 v[118:119], v[118:119], v[246:247] op_sel:[0,1] op_sel_hi:[1,1]
    v_pk_fma_f32 v[136:137], v[16:17], v[246:247], v[136:137] op_sel_hi:[1,0,1]
    v_pk_fma_f32 v[138:139], v[18:19], v[246:247], v[138:139] op_sel_hi:[1,0,1]
    v_pk_mul_f32 v[136:137], v[136:137], v[246:247] op_sel:[0,1] op_sel_hi:[1,1]
    buffer_load_dwordx4 a[28:31], v60, s[4:7], s50 offen offset:256 sc1
    v_pk_mul_f32 v[138:139], v[138:139], v[246:247] op_sel:[0,1] op_sel_hi:[1,1]
    v_mfma_f32_16x16x32_bf16 v[214:217], v[172:175], v[148:151], v[28:31]
    v_cvt_pk_bf16_f32 v152, v76, v77
    v_cvt_pk_bf16_f32 v153, v78, v79
    v_mfma_f32_16x16x32_bf16 v[68:71], v[166:169], v[148:151], v[32:35]
    v_cvt_pk_bf16_f32 v182, v116, v117
    v_cvt_pk_bf16_f32 v183, v118, v119
    v_cvt_pk_bf16_f32 v178, v96, v97
    v_cvt_pk_bf16_f32 v179, v98, v99
    v_cvt_pk_bf16_f32 v180, v136, v137
    v_cvt_pk_bf16_f32 v181, v138, v139
    v_and_b32 v154, v49, v182
    buffer_load_dwordx4 a[32:35], v60, s[4:7], s50 offen offset:512 sc1
    s_add_u32 s50, s50, 196608
    v_and_b32 v155, v49, v183
    ds_write_b128 v46, v[180:183] offset:3840
    s_waitcnt vmcnt(29)
    v_pk_fma_f32 v[80:81], v[4:5], v[248:249], v[80:81] op_sel_hi:[1,0,1]
    v_pk_fma_f32 v[82:83], v[6:7], v[248:249], v[82:83] op_sel_hi:[1,0,1]
    v_pk_mul_f32 v[80:81], v[80:81], v[248:249] op_sel:[0,1] op_sel_hi:[1,1]
    v_pk_mul_f32 v[82:83], v[82:83], v[248:249] op_sel:[0,1] op_sel_hi:[1,1]
    v_pk_fma_f32 v[100:101], v[8:9], v[248:249], v[100:101] op_sel_hi:[1,0,1]
    v_pk_fma_f32 v[102:103], v[10:11], v[248:249], v[102:103] op_sel_hi:[1,0,1]
    v_pk_mul_f32 v[100:101], v[100:101], v[248:249] op_sel:[0,1] op_sel_hi:[1,1]
    v_pk_mul_f32 v[102:103], v[102:103], v[248:249] op_sel:[0,1] op_sel_hi:[1,1]
    v_pk_fma_f32 v[120:121], v[12:13], v[248:249], v[120:121] op_sel_hi:[1,0,1]
    v_pk_fma_f32 v[122:123], v[14:15], v[248:249], v[122:123] op_sel_hi:[1,0,1]
    buffer_load_dwordx4 a[36:39], v60, s[4:7], s50 offen offset:0 sc1
    v_pk_mul_f32 v[120:121], v[120:121], v[248:249] op_sel:[0,1] op_sel_hi:[1,1]
    v_pk_mul_f32 v[122:123], v[122:123], v[248:249] op_sel:[0,1] op_sel_hi:[1,1]
    v_pk_fma_f32 v[140:141], v[16:17], v[248:249], v[140:141] op_sel_hi:[1,0,1]
    v_pk_fma_f32 v[142:143], v[18:19], v[248:249], v[142:143] op_sel_hi:[1,0,1]
    v_pk_mul_f32 v[140:141], v[140:141], v[248:249] op_sel:[0,1] op_sel_hi:[1,1]
    v_pk_mul_f32 v[142:143], v[142:143], v[248:249] op_sel:[0,1] op_sel_hi:[1,1]
    v_mfma_f32_16x16x32_bf16 v[218:221], v[178:181], v[152:155], v[28:31]
    v_cvt_pk_bf16_f32 v156, v80, v81
    v_cvt_pk_bf16_f32 v157, v82, v83
    v_mfma_f32_16x16x32_bf16 v[72:75], v[172:175], v[152:155], v[32:35]
    v_cvt_pk_bf16_f32 v188, v120, v121
    v_cvt_pk_bf16_f32 v189, v122, v123
    buffer_load_dwordx4 a[40:43], v60, s[4:7], s50 offen offset:256 sc1
    v_cvt_pk_bf16_f32 v184, v100, v101
    v_cvt_pk_bf16_f32 v185, v102, v103
    v_cvt_pk_bf16_f32 v186, v140, v141
    v_cvt_pk_bf16_f32 v187, v142, v143
    v_and_b32 v158, v49, v188
    v_and_b32 v159, v49, v189
    ds_write_b128 v46, v[186:189] offset:5120
    s_nop 0
    v_mfma_f32_16x16x32_bf16 v[222:225], v[184:187], v[156:159], v[28:31]
    ds_read_b64_tr_b16 v[190:191], v47 offset:0
    ds_read_b64_tr_b16 v[200:201], v48 offset:0
    v_mfma_f32_16x16x32_bf16 v[76:79], v[178:181], v[156:159], v[32:35]
    ds_read_b64_tr_b16 v[192:193], v47 offset:1280
    buffer_load_dwordx4 a[44:47], v60, s[4:7], s50 offen offset:512 sc1
    s_add_u32 s50, s50, 196608
    ds_read_b64_tr_b16 v[202:203], v48 offset:1280
    ds_read_b64_tr_b16 v[194:195], v47 offset:2560
    ds_read_b64_tr_b16 v[204:205], v48 offset:2560
    ds_read_b64_tr_b16 v[196:197], v47 offset:3840
    ds_read_b64_tr_b16 v[206:207], v48 offset:3840
    ds_read_b64_tr_b16 v[198:199], v47 offset:5120
    ds_read_b64_tr_b16 v[208:209], v48 offset:5120
    v_max_f32 v210, v210, v64
    v_max_f32 v211, v211, v65
    v_max_f32 v212, v212, v66
    v_max_f32 v213, v213, v67
    v_max3_f32 v20, v210, v211, v212
    v_max_f32 v20, v20, v213
    buffer_load_dwordx4 a[48:51], v60, s[4:7], s50 offen offset:0 sc1
    v_max_f32 v214, v214, v68
    v_max_f32 v215, v215, v69
    v_max_f32 v216, v216, v70
    v_max_f32 v217, v217, v71
    v_max3_f32 v21, v214, v215, v216
    v_max_f32 v21, v21, v217
    v_max_f32 v218, v218, v72
    v_max_f32 v219, v219, v73
    v_max_f32 v220, v220, v74
    v_max_f32 v221, v221, v75
    v_max3_f32 v22, v218, v219, v220
    v_max_f32 v22, v22, v221
    buffer_load_dwordx4 a[52:55], v60, s[4:7], s50 offen offset:256 sc1
    v_permlane32_swap_b32 v20, v21
    v_max_f32 v222, v222, v76
    v_max_f32 v223, v223, v77
    v_max_f32 v224, v224, v78
    v_max_f32 v225, v225, v79
    v_max3_f32 v23, v222, v223, v224
    v_max_f32 v23, v23, v225
    v_max_f32 v20, v20, v21
    v_pk_mul_f32 v[210:211], v[210:211], s[46:47] op_sel_hi:[1,0]
    v_permlane32_swap_b32 v22, v23
    v_max_f32 v22, v22, v23
    v_pk_mul_f32 v[212:213], v[212:213], s[46:47] op_sel_hi:[1,0]
    buffer_load_dwordx4 a[56:59], v60, s[4:7], s50 offen offset:512 sc1
    s_add_u32 s50, s50, 196608
    v_pk_mul_f32 v[214:215], v[214:215], s[46:47] op_sel_hi:[1,0]
    v_permlane16_swap_b32 v20, v22
    v_max_f32 v21, v20, v22
    v_mul_f32 v20, s46, v21
    v_mul_f32 v22, s46, v21
    v_pk_mul_f32 v[216:217], v[216:217], s[46:47] op_sel_hi:[1,0]
    v_pk_mul_f32 v[218:219], v[218:219], s[46:47] op_sel_hi:[1,0]
    v_permlane16_swap_b32 v20, v22
    v_mov_b32 v21, v20
    v_mov_b32 v23, v22
    v_pk_mul_f32 v[220:221], v[220:221], s[46:47] op_sel_hi:[1,0]
    v_pk_mul_f32 v[222:223], v[222:223], s[46:47] op_sel_hi:[1,0]
    buffer_load_dwordx4 a[60:63], v60, s[4:7], s50 offen offset:0 sc1
    v_permlane32_swap_b32 v20, v21
    v_permlane32_swap_b32 v22, v23
    v_pk_mul_f32 v[224:225], v[224:225], s[46:47] op_sel_hi:[1,0]
    v_pk_add_f32 v[210:211], v[210:211], v[20:21] op_sel:[0,0] op_sel_hi:[1,0] neg_lo:[0,1] neg_hi:[0,1]
    v_pk_add_f32 v[212:213], v[212:213], v[20:21] op_sel:[0,0] op_sel_hi:[1,0] neg_lo:[0,1] neg_hi:[0,1]
    v_pk_add_f32 v[214:215], v[214:215], v[20:21] op_sel:[0,1] op_sel_hi:[1,1] neg_lo:[0,1] neg_hi:[0,1]
    v_pk_add_f32 v[216:217], v[216:217], v[20:21] op_sel:[0,1] op_sel_hi:[1,1] neg_lo:[0,1] neg_hi:[0,1]
    v_pk_add_f32 v[218:219], v[218:219], v[22:23] op_sel:[0,0] op_sel_hi:[1,0] neg_lo:[0,1] neg_hi:[0,1]
    v_pk_add_f32 v[220:221], v[220:221], v[22:23] op_sel:[0,0] op_sel_hi:[1,0] neg_lo:[0,1] neg_hi:[0,1]
    v_pk_add_f32 v[222:223], v[222:223], v[22:23] op_sel:[0,1] op_sel_hi:[1,1] neg_lo:[0,1] neg_hi:[0,1]
    v_pk_add_f32 v[224:225], v[224:225], v[22:23] op_sel:[0,1] op_sel_hi:[1,1] neg_lo:[0,1] neg_hi:[0,1]
    s_waitcnt lgkmcnt(0)
    buffer_load_dwordx4 a[64:67], v60, s[4:7], s50 offen offset:256 sc1
    v_exp_f32 v210, v210
    v_exp_f32 v211, v211
    v_exp_f32 v212, v212
    v_exp_f32 v213, v213
    v_cvt_pk_bf16_f32 v6, v210, v211
    v_cvt_pk_bf16_f32 v7, v212, v213
    v_and_b32 v4, v44, v6
    v_and_b32 v5, v45, v7
    v_xor_b32 v6, v4, v6
    v_xor_b32 v7, v5, v7
    v_exp_f32 v214, v214
    v_exp_f32 v215, v215
    buffer_load_dwordx4 a[68:71], v60, s[4:7], s50 offen offset:512 sc1
    s_add_u32 s50, s50, 196608
    v_mfma_f32_16x16x32_bf16 v[116:119], v[40:43], v[4:7], 0
    v_exp_f32 v216, v216
    v_mfma_f32_16x16x32_bf16 v[84:87], v[190:193], v[4:7], 0
    v_exp_f32 v217, v217
    v_mfma_f32_16x16x32_bf16 v[100:103], v[200:203], v[4:7], 0
    v_cvt_pk_bf16_f32 v10, v214, v215
    v_cvt_pk_bf16_f32 v11, v216, v217
    v_and_b32 v8, v44, v10
    v_and_b32 v9, v45, v11
    v_xor_b32 v10, v8, v10
    v_xor_b32 v11, v9, v11
    v_exp_f32 v218, v218
    v_exp_f32 v219, v219
    v_mfma_f32_16x16x32_bf16 v[120:123], v[40:43], v[8:11], 0
    v_exp_f32 v220, v220
    v_mfma_f32_16x16x32_bf16 v[88:91], v[192:195], v[8:11], 0
    v_exp_f32 v221, v221
    v_mfma_f32_16x16x32_bf16 v[104:107], v[202:205], v[8:11], 0
    v_cvt_pk_bf16_f32 v14, v218, v219
    v_cvt_pk_bf16_f32 v15, v220, v221
    v_and_b32 v12, v44, v14
    v_and_b32 v13, v45, v15
    v_xor_b32 v14, v12, v14
    v_xor_b32 v15, v13, v15
    v_exp_f32 v222, v222
    v_exp_f32 v223, v223
    v_mfma_f32_16x16x32_bf16 v[124:127], v[40:43], v[12:15], 0
    v_exp_f32 v224, v224
    v_mfma_f32_16x16x32_bf16 v[92:95], v[194:197], v[12:15], 0
    v_exp_f32 v225, v225
    v_mfma_f32_16x16x32_bf16 v[108:111], v[204:207], v[12:15], 0
    v_cvt_pk_bf16_f32 v18, v222, v223
    v_cvt_pk_bf16_f32 v19, v224, v225
    v_and_b32 v16, v44, v18
    v_and_b32 v17, v45, v19
    v_xor_b32 v18, v16, v18
    v_xor_b32 v19, v17, v19
    v_rcp_f32 v116, v116
    v_rcp_f32 v120, v120
    v_mfma_f32_16x16x32_bf16 v[128:131], v[40:43], v[16:19], 0
    v_rcp_f32 v124, v124
    v_mfma_f32_16x16x32_bf16 v[96:99], v[196:199], v[16:19], 0
    v_mfma_f32_16x16x32_bf16 v[112:115], v[206:209], v[16:19], 0
    v_pk_mul_f32 v[84:85], v[84:85], v[116:117] op_sel_hi:[1,0]
    v_pk_mul_f32 v[86:87], v[86:87], v[116:117] op_sel_hi:[1,0]
    v_pk_mul_f32 v[100:101], v[100:101], v[116:117] op_sel_hi:[1,0]
    v_pk_mul_f32 v[102:103], v[102:103], v[116:117] op_sel_hi:[1,0]
    v_cvt_pk_bf16_f32 v144, v84, v85
    v_cvt_pk_bf16_f32 v145, v86, v87
    v_cvt_pk_bf16_f32 v146, v100, v101
    v_cvt_pk_bf16_f32 v147, v102, v103
    buffer_store_dwordx4 v[144:147], v50, s[4:7], s45 offen sc1
    buffer_store_dwordx2 v[144:145], v51, s[4:7], s47 offen sc1
    v_rcp_f32 v128, v128
    v_pk_mul_f32 v[88:89], v[88:89], v[120:121] op_sel_hi:[1,0]
    v_pk_mul_f32 v[90:91], v[90:91], v[120:121] op_sel_hi:[1,0]
    v_pk_mul_f32 v[104:105], v[104:105], v[120:121] op_sel_hi:[1,0]
    v_pk_mul_f32 v[106:107], v[106:107], v[120:121] op_sel_hi:[1,0]
    v_cvt_pk_bf16_f32 v148, v88, v89
    v_cvt_pk_bf16_f32 v149, v90, v91
    v_cvt_pk_bf16_f32 v150, v104, v105
    v_cvt_pk_bf16_f32 v151, v106, v107
    s_add_u32 s45, s45, 20480
    s_add_u32 s47, s47, 20480
    buffer_store_dwordx4 v[148:151], v50, s[4:7], s45 offen sc1
    buffer_store_dwordx2 v[148:149], v51, s[4:7], s47 offen sc1
    v_pk_mul_f32 v[92:93], v[92:93], v[124:125] op_sel_hi:[1,0]
    v_pk_mul_f32 v[94:95], v[94:95], v[124:125] op_sel_hi:[1,0]
    v_pk_mul_f32 v[108:109], v[108:109], v[124:125] op_sel_hi:[1,0]
    v_pk_mul_f32 v[110:111], v[110:111], v[124:125] op_sel_hi:[1,0]
    v_cvt_pk_bf16_f32 v152, v92, v93
    v_cvt_pk_bf16_f32 v153, v94, v95
    v_cvt_pk_bf16_f32 v154, v108, v109
    v_cvt_pk_bf16_f32 v155, v110, v111
    s_add_u32 s45, s45, 20480
    s_add_u32 s47, s47, 20480
    buffer_store_dwordx4 v[152:155], v50, s[4:7], s45 offen sc1
    buffer_store_dwordx2 v[152:153], v51, s[4:7], s47 offen sc1
    v_pk_mul_f32 v[96:97], v[96:97], v[128:129] op_sel_hi:[1,0]
    v_pk_mul_f32 v[98:99], v[98:99], v[128:129] op_sel_hi:[1,0]
    v_pk_mul_f32 v[112:113], v[112:113], v[128:129] op_sel_hi:[1,0]
    v_pk_mul_f32 v[114:115], v[114:115], v[128:129] op_sel_hi:[1,0]
    v_cvt_pk_bf16_f32 v156, v96, v97
    v_cvt_pk_bf16_f32 v157, v98, v99
    v_cvt_pk_bf16_f32 v158, v112, v113
    v_cvt_pk_bf16_f32 v159, v114, v115
    s_add_u32 s45, s45, 20480
    s_add_u32 s47, s47, 20480
    buffer_store_dwordx4 v[156:159], v50, s[4:7], s45 offen sc1
    buffer_store_dwordx2 v[156:157], v51, s[4:7], s47 offen sc1
    s_add_u32 m0, s55, 20480
    s_nop 0
    buffer_load_dwordx4 v61, s[4:7], s51 offen offset:0 sc1 lds
    s_add_u32 m0, s55, 24320
    s_nop 0
    buffer_load_dwordx4 v61, s[4:7], s51 offen offset:256 sc1 lds
    s_add_u32 m0, s55, 28160
    s_nop 0
    buffer_load_dwordx4 v61, s[4:7], s51 offen offset:512 sc1 lds
    s_add_u32 m0, s55, 15616
    s_nop 0
    buffer_load_dwordx4 v61, s[4:7], s51 offen offset:768 sc1 lds
    s_add_u32 m0, s55, 64512
    s_nop 0
    buffer_load_dwordx4 v61, s[4:7], s51 offen offset:1024 sc1 lds
    s_add_u32 s51, s51, 40960
    s_add_u32 m0, s54, 69632
    s_nop 0
    buffer_load_dwordx4 v57, s[16:19], s53 offen offset:0 lds
    v_mul_u32_u24 v24, 160, v1
    v_lshl_add_u32 v24, v2, 3, v24
    v_add_u32 v24, s54, v24
    v_add_u32 v24, 69632, v24
    v_add_u32 v25, 0x10000, v3
    s_lshl_b32 s30, s21, 3
    s_lshl_b32 s31, s26, 2
    s_add_u32 s30, s30, s31
    s_add_u32 s56, s30, s20
    s_mul_i32 s30, s56, 20480
    s_add_u32 s32, s30, 14680064
    s_add_u32 s33, s32, 16384
    s_mul_i32 s31, s28, 2560
    s_add_u32 s34, s30, s31
    s_add_u32 s34, s34, 17825792
    s_lshl_b32 s35, s56, 3
    s_add_u32 s35, s35, s28
    s_lshl_b32 s35, s35, 7
    s_add_u32 s35, s35, 262144
    v_lshlrev_b32 v36, 3, v0
    v_lshrrev_b32 v37, 1, v2
    v_lshlrev_b32 v38, 4, v1
    v_lshl_add_u32 v38, v37, 8, v38
    v_and_b32 v39, 1, v2
    v_lshl_add_u32 v38, v39, 3, v38
    v_lshlrev_b32 v37, 6, v37
    v_lshl_add_u32 v37, v1, 2, v37
    v_cmp_eq_u32 vcc, 0, v39
    v_mov_b32 v39, 2146435072
    v_lshlrev_b32 v56, 7, v1
    v_cndmask_b32 v37, v39, v37, vcc
    s_lshl_b32 s62, s21, 11
    s_add_u32 s62, s62, 98304
    s_waitcnt vmcnt(6)
    s_barrier
    buffer_store_dword v55, v53, s[4:7], 0 offen sc1
    buffer_load_dwordx4 v58, s[16:19], s53 offen offset:1024 lds
    buffer_load_dwordx4 v59, s[16:19], s53 offen offset:2048 lds
    buffer_load_dwordx4 a[72:75], v60, s[4:7], s50 offen offset:0 sc1
    buffer_load_dwordx4 a[76:79], v60, s[4:7], s50 offen offset:256 sc1
    buffer_load_dwordx4 a[80:83], v60, s[4:7], s50 offen offset:512 sc1
    s_add_u32 s50, s50, 196608
    buffer_load_dwordx4 a[84:87], v60, s[4:7], s50 offen offset:0 sc1
    buffer_load_dwordx4 a[88:91], v60, s[4:7], s50 offen offset:256 sc1
    buffer_load_dwordx4 a[92:95], v60, s[4:7], s50 offen offset:512 sc1
    s_add_u32 s50, s50, 196608
    buffer_load_dwordx4 a[96:99], v60, s[4:7], s50 offen offset:0 sc1
    buffer_load_dwordx4 a[100:103], v60, s[4:7], s50 offen offset:256 sc1
    buffer_load_dwordx4 a[104:107], v60, s[4:7], s50 offen offset:512 sc1
    s_add_u32 s50, s50, 196608
    buffer_load_dwordx4 a[108:111], v60, s[4:7], s50 offen offset:0 sc1
    buffer_load_dwordx4 a[112:115], v60, s[4:7], s50 offen offset:256 sc1
    buffer_load_dwordx4 a[116:119], v60, s[4:7], s50 offen offset:512 sc1
    s_add_u32 s50, s50, 196608
    buffer_load_dword v44, v56, s[4:7], s62 offen sc1
    s_waitcnt vmcnt(0)
    v_cmp_ne_u32 vcc, s24, v44
    s_nop 0
    s_cbranch_vccnz L_g2
L_gx2:
    buffer_load_dwordx4 v[172:175], v3, s[4:7], s32 offen offset:0 sc1
    buffer_load_dwordx4 v[176:179], v3, s[4:7], s32 offen offset:1024 sc1
    buffer_load_dwordx4 v[180:183], v3, s[4:7], s32 offen offset:2048 sc1
    buffer_load_dwordx4 v[184:187], v3, s[4:7], s32 offen offset:3072 sc1
    buffer_load_dwordx2 v[188:189], v36, s[4:7], s33 offen offset:0 sc1
    buffer_load_dwordx2 v[190:191], v36, s[4:7], s33 offen offset:512 sc1
    s_add_u32 s32, s32, 4096
    buffer_load_dwordx4 v[192:195], v3, s[4:7], s32 offen offset:0 sc1
    buffer_load_dwordx4 v[196:199], v3, s[4:7], s32 offen offset:1024 sc1
    buffer_load_dwordx4 v[200:203], v3, s[4:7], s32 offen offset:2048 sc1
    buffer_load_dwordx4 v[204:207], v3, s[4:7], s32 offen offset:3072 sc1
    s_barrier
    ds_read_b64 v[26:27], v24 offset:0
    ds_read_b64 v[28:29], v24 offset:32
    ds_read_b64 v[30:31], v24 offset:64
    ds_read_b64 v[32:33], v24 offset:96
    ds_read_b64 v[34:35], v24 offset:128
    ds_read_b128 v[64:67], v3 offset:36864
    ds_read_b128 v[68:71], v3 offset:40960
    ds_read_b128 v[72:75], v3 offset:45056
    ds_read_b128 v[76:79], v3 offset:32768
    ds_read_b128 v[80:83], v3 offset:53248
    ds_read_b128 v[84:87], v3 offset:57344
    ds_read_b128 v[88:91], v3 offset:61440
    ds_read_b128 v[92:95], v3 offset:49152
    ds_read_b128 v[96:99], v25 offset:20480
    ds_read_b128 v[100:103], v25 offset:24576
    s_waitcnt lgkmcnt(14)
    v_lshlrev_b32 v4, 16, v26
    v_and_b32 v5, 0xffff0000, v26
    v_lshlrev_b32 v6, 16, v27
    v_and_b32 v7, 0xffff0000, v27
    s_waitcnt lgkmcnt(13)
    v_lshlrev_b32 v8, 16, v28
    v_and_b32 v9, 0xffff0000, v28
    v_lshlrev_b32 v10, 16, v29
    v_and_b32 v11, 0xffff0000, v29
    s_waitcnt lgkmcnt(12)
    v_lshlrev_b32 v12, 16, v30
    v_and_b32 v13, 0xffff0000, v30
    v_lshlrev_b32 v14, 16, v31
    v_and_b32 v15, 0xffff0000, v31
    s_waitcnt lgkmcnt(11)
    v_lshlrev_b32 v16, 16, v32
    v_and_b32 v17, 0xffff0000, v32
    v_lshlrev_b32 v18, 16, v33
    v_and_b32 v19, 0xffff0000, v33
    s_waitcnt lgkmcnt(10)
    v_lshlrev_b32 v20, 16, v34
    v_and_b32 v21, 0xffff0000, v34
    v_lshlrev_b32 v22, 16, v35
    v_and_b32 v23, 0xffff0000, v35
    ds_read_b128 v[104:107], v25 offset:28672
    ds_read_b128 v[108:111], v25 offset:16384
    ds_read_b128 v[112:115], v3 offset:4096
    ds_read_b128 v[116:119], v3 offset:8192
    ds_read_b128 v[120:123], v3 offset:12288
    ds_read_b128 v[124:127], v3 offset:0
    ds_read_b128 v[128:131], v25 offset:36864
    ds_read_b128 v[132:135], v25 offset:40960
    ds_read_b128 v[136:139], v25 offset:45056
    ds_read_b128 v[140:143], v25 offset:32768
    ds_read_b128 v[144:147], v3 offset:20480
    ds_read_b128 v[148:151], v3 offset:24576
    ds_read_b128 v[152:155], v3 offset:28672
    ds_read_b128 v[156:159], v3 offset:16384
    ds_read_b128 v[160:163], v25 offset:0
    ds_read_b128 v[164:167], v3 offset:37888
    ds_read_b128 v[168:171], v3 offset:41984
    v_add_u32 v53, 32768, v53
    v_add_u32 v54, 32768, v54
    s_add_u32 s62, s62, 32768
    s_waitcnt vmcnt(9) lgkmcnt(15)
    v_mfma_f32_16x16x32_bf16 v[4:7], v[64:67], v[172:175], v[4:7]
    buffer_load_dwordx2 v[208:209], v36, s[4:7], s33 offen offset:1024 sc1
    v_mfma_f32_16x16x32_bf16 v[8:11], v[68:71], v[172:175], v[8:11]
    ds_read_b128 v[64:67], v3 offset:46080
    v_mfma_f32_16x16x32_bf16 v[12:15], v[72:75], v[172:175], v[12:15]
    ds_read_b128 v[68:71], v3 offset:33792
    v_mfma_f32_16x16x32_bf16 v[16:19], v[76:79], v[172:175], v[16:19]
    ds_read_b128 v[72:75], v3 offset:54272
    v_mfma_f32_16x16x32_bf16 v[20:23], v[80:83], v[172:175], v[20:23]
    s_waitcnt vmcnt(9)
    ds_read_b128 v[76:79], v3 offset:58368
    v_mfma_f32_16x16x32_bf16 v[4:7], v[84:87], v[176:179], v[4:7]
    buffer_load_dwordx2 v[210:211], v36, s[4:7], s33 offen offset:1536 sc1
    v_mfma_f32_16x16x32_bf16 v[8:11], v[88:91], v[176:179], v[8:11]
    s_add_u32 s32, s32, 4096
    ds_read_b128 v[80:83], v3 offset:62464
    ds_read_b128 v[84:87], v3 offset:50176
    v_mfma_f32_16x16x32_bf16 v[12:15], v[92:95], v[176:179], v[12:15]
L_hop2:
    s_cbranch_execz L_hop6
    ds_read_b128 v[88:91], v25 offset:21504
    v_mfma_f32_16x16x32_bf16 v[16:19], v[96:99], v[176:179], v[16:19]
    ds_read_b128 v[92:95], v25 offset:25600
    v_mfma_f32_16x16x32_bf16 v[20:23], v[100:103], v[176:179], v[20:23]
    s_waitcnt vmcnt(9) lgkmcnt(15)
    v_mfma_f32_16x16x32_bf16 v[4:7], v[104:107], v[180:183], v[4:7]
    buffer_load_dwordx4 v[212:215], v3, s[4:7], s32 offen offset:0 sc1
    v_mfma_f32_16x16x32_bf16 v[8:11], v[108:111], v[180:183], v[8:11]
    ds_read_b128 v[96:99], v25 offset:29696
    ds_read_b128 v[100:103], v25 offset:17408
    v_mfma_f32_16x16x32_bf16 v[12:15], v[112:115], v[180:183], v[12:15]
    ds_read_b128 v[104:107], v3 offset:5120
    v_mfma_f32_16x16x32_bf16 v[16:19], v[116:119], v[180:183], v[16:19]
    buffer_load_dwordx4 v[216:219], v3, s[4:7], s32 offen offset:1024 sc1
    v_mfma_f32_16x16x32_bf16 v[20:23], v[120:123], v[180:183], v[20:23]
    s_waitcnt vmcnt(10)
    ds_read_b128 v[108:111], v3 offset:9216
    ds_read_b128 v[112:115], v3 offset:13312
    v_mfma_f32_16x16x32_bf16 v[4:7], v[124:127], v[184:187], v[4:7]
    ds_read_b128 v[116:119], v3 offset:1024
    v_mfma_f32_16x16x32_bf16 v[8:11], v[128:131], v[184:187], v[8:11]
    ds_read_b128 v[120:123], v25 offset:37888
    v_mfma_f32_16x16x32_bf16 v[12:15], v[132:135], v[184:187], v[12:15]
    buffer_load_dwordx4 v[220:223], v3, s[4:7], s32 offen offset:2048 sc1
    v_mfma_f32_16x16x32_bf16 v[16:19], v[136:139], v[184:187], v[16:19]
    ds_read_b128 v[124:127], v25 offset:41984
    v_mfma_f32_16x16x32_bf16 v[20:23], v[140:143], v[184:187], v[20:23]
    s_waitcnt vmcnt(9) lgkmcnt(15)
    ds_read_b128 v[128:131], v25 offset:46080
    v_mfma_f32_16x16x32_bf16 v[4:7], v[144:147], v[188:191], v[4:7]
    ds_read_b128 v[132:135], v25 offset:33792
    v_mfma_f32_16x16x32_bf16 v[8:11], v[148:151], v[188:191], v[8:11]
    buffer_load_dwordx4 v[224:227], v3, s[4:7], s32 offen offset:3072 sc1
    v_mfma_f32_16x16x32_bf16 v[12:15], v[152:155], v[188:191], v[12:15]
    ds_read_b128 v[136:139], v3 offset:21504
    ds_read_b128 v[140:143], v3 offset:25600
    v_mfma_f32_16x16x32_bf16 v[16:19], v[156:159], v[188:191], v[16:19]
    ds_read_b128 v[144:147], v3 offset:29696
    v_mfma_f32_16x16x32_bf16 v[20:23], v[160:163], v[188:191], v[20:23]
    s_waitcnt vmcnt(9) lgkmcnt(15)
    ds_read_b128 v[148:151], v3 offset:17408
    v_mfma_f32_16x16x32_bf16 v[4:7], v[164:167], v[192:195], v[4:7]
    buffer_load_dwordx2 v[228:229], v36, s[4:7], s33 offen offset:2048 sc1
    v_mfma_f32_16x16x32_bf16 v[8:11], v[168:171], v[192:195], v[8:11]
    ds_read_b128 v[152:155], v25 offset:1024
    ds_read_b128 v[156:159], v3 offset:38912
    v_mfma_f32_16x16x32_bf16 v[12:15], v[64:67], v[192:195], v[12:15]
    v_mfma_f32_16x16x32_bf16 v[16:19], v[68:71], v[192:195], v[16:19]
    ds_read_b128 v[160:163], v3 offset:43008
    v_mfma_f32_16x16x32_bf16 v[20:23], v[72:75], v[192:195], v[20:23]
    s_waitcnt vmcnt(9) lgkmcnt(15)
    ds_read_b128 v[164:167], v3 offset:47104
    v_mfma_f32_16x16x32_bf16 v[4:7], v[76:79], v[196:199], v[4:7]
    buffer_load_dwordx2 v[230:231], v36, s[4:7], s33 offen offset:2560 sc1
    v_mfma_f32_16x16x32_bf16 v[8:11], v[80:83], v[196:199], v[8:11]
    s_add_u32 s32, s32, 4096
    ds_read_b128 v[168:171], v3 offset:34816
    ds_read_b128 v[64:67], v3 offset:55296
    v_mfma_f32_16x16x32_bf16 v[12:15], v[84:87], v[196:199], v[12:15]
    ds_read_b128 v[68:71], v3 offset:59392
    v_mfma_f32_16x16x32_bf16 v[16:19], v[88:91], v[196:199], v[16:19]
    buffer_load_dwordx4 v[232:235], v3, s[4:7], s32 offen offset:0 sc1
    v_mfma_f32_16x16x32_bf16 v[20:23], v[92:95], v[196:199], v[20:23]
    s_waitcnt vmcnt(10) lgkmcnt(15)
    ds_read_b128 v[72:75], v3 offset:63488
    ds_read_b128 v[76:79], v3 offset:51200
    v_mfma_f32_16x16x32_bf16 v[4:7], v[96:99], v[200:203], v[4:7]
    ds_read_b128 v[80:83], v25 offset:22528
    v_mfma_f32_16x16x32_bf16 v[8:11], v[100:103], v[200:203], v[8:11]
    buffer_load_dwordx4 v[236:239], v3, s[4:7], s32 offen offset:1024 sc1
    v_mfma_f32_16x16x32_bf16 v[12:15], v[104:107], v[200:203], v[12:15]
    ds_read_b128 v[84:87], v25 offset:26624
    v_mfma_f32_16x16x32_bf16 v[16:19], v[108:111], v[200:203], v[16:19]
    ds_read_b128 v[88:91], v25 offset:30720
    v_mfma_f32_16x16x32_bf16 v[20:23], v[112:115], v[200:203], v[20:23]
    s_waitcnt vmcnt(10) lgkmcnt(15)
    ds_read_b128 v[92:95], v25 offset:18432
    v_mfma_f32_16x16x32_bf16 v[4:7], v[116:119], v[204:207], v[4:7]
    ds_read_b128 v[96:99], v3 offset:6144
    v_mfma_f32_16x16x32_bf16 v[8:11], v[120:123], v[204:207], v[8:11]
    buffer_load_dwordx4 v[240:243], v3, s[4:7], s32 offen offset:2048 sc1
    v_mfma_f32_16x16x32_bf16 v[12:15], v[124:127], v[204:207], v[12:15]
    ds_read_b128 v[100:103], v3 offset:10240
    ds_read_b128 v[104:107], v3 offset:14336
    v_mfma_f32_16x16x32_bf16 v[16:19], v[128:131], v[204:207], v[16:19]
    ds_read_b128 v[108:111], v3 offset:2048
    v_mfma_f32_16x16x32_bf16 v[20:23], v[132:135], v[204:207], v[20:23]
    s_waitcnt vmcnt(9) lgkmcnt(15)
    ds_read_b128 v[112:115], v25 offset:38912
    v_mfma_f32_16x16x32_bf16 v[4:7], v[136:139], v[208:211], v[4:7]
    buffer_load_dwordx4 v[244:247], v3, s[4:7], s32 offen offset:3072 sc1
    v_mfma_f32_16x16x32_bf16 v[8:11], v[140:143], v[208:211], v[8:11]
    ds_read_b128 v[116:119], v25 offset:43008
    v_mfma_f32_16x16x32_bf16 v[12:15], v[144:147], v[208:211], v[12:15]
    ds_read_b128 v[120:123], v25 offset:47104
    v_mfma_f32_16x16x32_bf16 v[16:19], v[148:151], v[208:211], v[16:19]
    ds_read_b128 v[124:127], v25 offset:34816
    v_mfma_f32_16x16x32_bf16 v[20:23], v[152:155], v[208:211], v[20:23]
    s_waitcnt vmcnt(9) lgkmcnt(15)
    ds_read_b128 v[128:131], v3 offset:22528
    v_mfma_f32_16x16x32_bf16 v[4:7], v[156:159], v[212:215], v[4:7]
    buffer_load_dwordx2 v[248:249], v36, s[4:7], s33 offen offset:3072 sc1
    v_mfma_f32_16x16x32_bf16 v[8:11], v[160:163], v[212:215], v[8:11]
    ds_read_b128 v[132:135], v3 offset:26624
    ds_read_b128 v[136:139], v3 offset:30720
    v_mfma_f32_16x16x32_bf16 v[12:15], v[164:167], v[212:215], v[12:15]
    ds_read_b128 v[140:143], v3 offset:18432
    v_mfma_f32_16x16x32_bf16 v[16:19], v[168:171], v[212:215], v[16:19]
    buffer_load_dwordx2 v[250:251], v36, s[4:7], s33 offen offset:3584 sc1
    v_mfma_f32_16x16x32_bf16 v[20:23], v[64:67], v[212:215], v[20:23]
    s_waitcnt vmcnt(10) lgkmcnt(14)
    ds_read_b128 v[144:147], v25 offset:2048
    v_mfma_f32_16x16x32_bf16 v[4:7], v[68:71], v[216:219], v[4:7]
    ds_read_b128 v[148:151], v3 offset:39936
    v_mfma_f32_16x16x32_bf16 v[8:11], v[72:75], v[216:219], v[8:11]
    ds_read_b128 v[152:155], v3 offset:44032
    v_mfma_f32_16x16x32_bf16 v[12:15], v[76:79], v[216:219], v[12:15]
    buffer_load_dwordx4 a[120:123], v60, s[4:7], s50 offen offset:0 sc1
    v_mfma_f32_16x16x32_bf16 v[16:19], v[80:83], v[216:219], v[16:19]
    ds_read_b128 v[156:159], v3 offset:48128
    ds_read_b128 v[160:163], v3 offset:35840
    v_mfma_f32_16x16x32_bf16 v[20:23], v[84:87], v[216:219], v[20:23]
    s_waitcnt vmcnt(10) lgkmcnt(14)
    ds_read_b128 v[164:167], v3 offset:56320
    v_mfma_f32_16x16x32_bf16 v[4:7], v[88:91], v[220:223], v[4:7]
    ds_read_b128 v[168:171], v3 offset:60416
    v_mfma_f32_16x16x32_bf16 v[8:11], v[92:95], v[220:223], v[8:11]
    buffer_load_dwordx4 a[124:127], v60, s[4:7], s50 offen offset:256 sc1
    v_mfma_f32_16x16x32_bf16 v[12:15], v[96:99], v[220:223], v[12:15]
    ds_read_b128 v[64:67], v3 offset:64512
    ds_read_b128 v[68:71], v3 offset:52224
    v_mfma_f32_16x16x32_bf16 v[16:19], v[100:103], v[220:223], v[16:19]
    v_mfma_f32_16x16x32_bf16 v[20:23], v[104:107], v[220:223], v[20:23]
    s_waitcnt vmcnt(10) lgkmcnt(13)
    ds_read_b128 v[72:75], v25 offset:23552
    v_mfma_f32_16x16x32_bf16 v[4:7], v[108:111], v[224:227], v[4:7]
    buffer_load_dwordx4 a[128:131], v60, s[4:7], s50 offen offset:512 sc1
    v_mfma_f32_16x16x32_bf16 v[8:11], v[112:115], v[224:227], v[8:11]
    s_add_u32 s50, s50, 196608
    ds_read_b128 v[76:79], v25 offset:27648
    ds_read_b128 v[80:83], v25 offset:31744
    v_mfma_f32_16x16x32_bf16 v[12:15], v[116:119], v[224:227], v[12:15]
    ds_read_b128 v[84:87], v25 offset:19456
    v_mfma_f32_16x16x32_bf16 v[16:19], v[120:123], v[224:227], v[16:19]
    ds_read_b128 v[88:91], v3 offset:7168
    v_mfma_f32_16x16x32_bf16 v[20:23], v[124:127], v[224:227], v[20:23]
    s_waitcnt vmcnt(9) lgkmcnt(13)
    ds_read_b128 v[92:95], v3 offset:11264
    v_mfma_f32_16x16x32_bf16 v[4:7], v[128:131], v[228:231], v[4:7]
    buffer_load_dwordx4 a[132:135], v60, s[4:7], s50 offen offset:0 sc1
    v_mfma_f32_16x16x32_bf16 v[8:11], v[132:135], v[228:231], v[8:11]
    ds_read_b128 v[96:99], v3 offset:15360
    ds_read_b128 v[100:103], v3 offset:3072
    v_mfma_f32_16x16x32_bf16 v[12:15], v[136:139], v[228:231], v[12:15]
    buffer_load_dwordx4 a[136:139], v60, s[4:7], s50 offen offset:256 sc1
    v_mfma_f32_16x16x32_bf16 v[16:19], v[140:143], v[228:231], v[16:19]
    ds_read_b128 v[104:107], v25 offset:39936
    v_mfma_f32_16x16x32_bf16 v[20:23], v[144:147], v[228:231], v[20:23]
    s_waitcnt vmcnt(10) lgkmcnt(12)
    ds_read_b128 v[108:111], v25 offset:44032
    v_mfma_f32_16x16x32_bf16 v[4:7], v[148:151], v[232:235], v[4:7]
    ds_read_b128 v[112:115], v25 offset:48128
    v_mfma_f32_16x16x32_bf16 v[8:11], v[152:155], v[232:235], v[8:11]
    ds_read_b128 v[116:119], v25 offset:35840
    v_mfma_f32_16x16x32_bf16 v[12:15], v[156:159], v[232:235], v[12:15]
    buffer_load_dwordx4 a[140:143], v60, s[4:7], s50 offen offset:512 sc1
    v_mfma_f32_16x16x32_bf16 v[16:19], v[160:163], v[232:235], v[16:19]
    s_add_u32 s50, s50, 196608
    ds_read_b128 v[120:123], v3 offset:23552
    ds_read_b128 v[124:127], v3 offset:27648
    v_mfma_f32_16x16x32_bf16 v[20:23], v[164:167], v[232:235], v[20:23]
    s_waitcnt vmcnt(10) lgkmcnt(12)
    ds_read_b128 v[128:131], v3 offset:31744
    v_mfma_f32_16x16x32_bf16 v[4:7], v[168:171], v[236:239], v[4:7]
    ds_read_b128 v[132:135], v3 offset:19456
    v_mfma_f32_16x16x32_bf16 v[8:11], v[64:67], v[236:239], v[8:11]
    buffer_load_dwordx4 a[144:147], v60, s[4:7], s50 offen offset:0 sc1
    v_mfma_f32_16x16x32_bf16 v[12:15], v[68:71], v[236:239], v[12:15]
    ds_read_b128 v[136:139], v25 offset:3072
    v_mfma_f32_16x16x32_bf16 v[16:19], v[72:75], v[236:239], v[16:19]
    v_mfma_f32_16x16x32_bf16 v[20:23], v[76:79], v[236:239], v[20:23]
    s_waitcnt vmcnt(10) lgkmcnt(10)
    v_mfma_f32_16x16x32_bf16 v[4:7], v[80:83], v[240:243], v[4:7]
    buffer_load_dwordx4 a[148:151], v60, s[4:7], s50 offen offset:256 sc1
    v_mfma_f32_16x16x32_bf16 v[8:11], v[84:87], v[240:243], v[8:11]
    v_mfma_f32_16x16x32_bf16 v[12:15], v[88:91], v[240:243], v[12:15]
    v_mfma_f32_16x16x32_bf16 v[16:19], v[92:95], v[240:243], v[16:19]
    buffer_load_dwordx4 a[152:155], v60, s[4:7], s50 offen offset:512 sc1
    v_mfma_f32_16x16x32_bf16 v[20:23], v[96:99], v[240:243], v[20:23]
    s_waitcnt vmcnt(11) lgkmcnt(5)
    s_add_u32 s50, s50, 196608
    v_mfma_f32_16x16x32_bf16 v[4:7], v[100:103], v[244:247], v[4:7]
    v_mfma_f32_16x16x32_bf16 v[8:11], v[104:107], v[244:247], v[8:11]
    v_mfma_f32_16x16x32_bf16 v[12:15], v[108:111], v[244:247], v[12:15]
    buffer_load_dwordx4 a[156:159], v60, s[4:7], s50 offen offset:0 sc1
    v_mfma_f32_16x16x32_bf16 v[16:19], v[112:115], v[244:247], v[16:19]
    v_mfma_f32_16x16x32_bf16 v[20:23], v[116:119], v[244:247], v[20:23]
    s_waitcnt vmcnt(10) lgkmcnt(0)
    v_mfma_f32_16x16x32_bf16 v[4:7], v[120:123], v[248:251], v[4:7]
    v_mfma_f32_16x16x32_bf16 v[8:11], v[124:127], v[248:251], v[8:11]
    v_mfma_f32_16x16x32_bf16 v[12:15], v[128:131], v[248:251], v[12:15]
    v_mfma_f32_16x16x32_bf16 v[16:19], v[132:135], v[248:251], v[16:19]
    v_mfma_f32_16x16x32_bf16 v[20:23], v[136:139], v[248:251], v[20:23]
    v_mov_b32 v42, 0x3f803f80
    v_mov_b32 v40, 0
    v_mov_b32 v41, 0
    s_nop 0
    v_cvt_pk_bf16_f32 v26, v4, v5
    v_cvt_pk_bf16_f32 v27, v6, v7
    v_cvt_pk_bf16_f32 v28, v8, v9
    v_cvt_pk_bf16_f32 v29, v10, v11
    v_cvt_pk_bf16_f32 v30, v12, v13
    v_cvt_pk_bf16_f32 v31, v14, v15
    v_cvt_pk_bf16_f32 v32, v16, v17
    v_cvt_pk_bf16_f32 v33, v18, v19
    v_cvt_pk_bf16_f32 v34, v20, v21
    v_cvt_pk_bf16_f32 v35, v22, v23
    v_dot2c_f32_bf16 v40, v26, v42
    v_dot2c_f32_bf16 v41, v26, v26
    v_dot2c_f32_bf16 v40, v27, v42
    v_dot2c_f32_bf16 v41, v27, v27
    v_dot2c_f32_bf16 v40, v28, v42
    v_dot2c_f32_bf16 v41, v28, v28
    v_dot2c_f32_bf16 v40, v29, v42
    v_dot2c_f32_bf16 v41, v29, v29
    v_dot2c_f32_bf16 v40, v30, v42
    v_dot2c_f32_bf16 v41, v30, v30
    v_dot2c_f32_bf16 v40, v31, v42
    v_dot2c_f32_bf16 v41, v31, v31
    v_dot2c_f32_bf16 v40, v32, v42
    v_dot2c_f32_bf16 v41, v32, v32
    v_dot2c_f32_bf16 v40, v33, v42
    v_dot2c_f32_bf16 v41, v33, v33
    v_dot2c_f32_bf16 v40, v34, v42
    v_dot2c_f32_bf16 v41, v34, v34
    v_dot2c_f32_bf16 v40, v35, v42
    v_dot2c_f32_bf16 v41, v35, v35
    buffer_store_dwordx4 v[26:29], v3, s[4:7], s34 offen sc1
    s_nop 1
    v_permlane32_swap_b32 v40, v41
    v_add_f32 v40, v40, v41
    v_mov_b32 v41, v40
    buffer_store_dwordx4 v[30:33], v3, s[4:7], s34 offen offset:1024 sc1
    buffer_store_dwordx2 v[34:35], v38, s[4:7], s34 offen offset:2048 sc1
    v_permlane16_swap_b32 v41, v40
    v_add_f32 v40, v40, v41
    buffer_store_dword v40, v37, s[4:7], s35 offen sc1
    buffer_load_dwordx4 a[160:163], v60, s[4:7], s50 offen offset:256 sc1
    buffer_load_dwordx4 a[164:167], v60, s[4:7], s50 offen offset:512 sc1
    s_add_u32 s50, s50, 196608
    buffer_load_dwordx4 a[168:171], v60, s[4:7], s50 offen offset:0 sc1
    buffer_load_dwordx4 a[172:175], v60, s[4:7], s50 offen offset:256 sc1
    buffer_load_dwordx4 a[176:179], v60, s[4:7], s50 offen offset:512 sc1
    s_add_u32 s50, s50, 196608
    buffer_load_dwordx4 a[180:183], v60, s[4:7], s50 offen offset:0 sc1
    v_mul_u32_u24 v24, 336, v1
    v_lshl_add_u32 v24, v2, 4, v24
    s_mul_i32 s30, s20, 5376
    s_add_u32 s30, s30, 140288
    v_add_u32 v24, s30, v24
    ds_write_b128 v24, v[4:7] offset:0
    ds_write_b128 v24, v[8:11] offset:64
    ds_write_b128 v24, v[12:15] offset:128
    ds_write_b128 v24, v[16:19] offset:192
    ds_write_b128 v24, v[20:23] offset:256
    s_waitcnt vmcnt(6) lgkmcnt(0)
    s_barrier
    buffer_store_dword v55, v53, s[4:7], 0 offen sc1
    s_add_u32 s57, s52, 245760
    s_or_b32 s60, s2, s20
    s_cselect_b32 s60, 2146435072, 0
    v_mov_b32 v105, s24
    s_mov_b64 exec, 1
    buffer_store_dword v105, off, s[4:7], s60 sc1
    s_mov_b64 exec, -1
    buffer_load_dwordx4 a[184:187], v60, s[4:7], s50 offen offset:256 sc1
    v_mov_b32 v16, 0x3f803f80
    v_mov_b32 v17, 0x3f803f80
    v_mov_b32 v18, 0x3f803f80
    v_mov_b32 v19, 0x3f803f80
    s_mul_i32 s30, s21, 163840
    s_mul_i32 s31, s20, 5120
    buffer_load_dwordx4 a[188:191], v60, s[4:7], s50 offen offset:512 sc1
    s_add_u32 s50, s50, 196608
    s_add_u32 s40, s30, s31
    s_add_u32 s40, s40, 17825792
    s_mov_b32 s41, s31
    v_add_u32 v24, 4096, v3
    v_lshrrev_b32 v100, 1, v2
    v_and_b32 v101, 31, v0
    buffer_load_dwordx4 a[192:195], v60, s[4:7], s50 offen offset:0 sc1
    v_lshlrev_b32 v101, 2, v101
    v_lshl_add_u32 v101, v100, 10, v101
    s_lshl_b32 s30, s21, 2
    s_add_u32 s30, s30, s20
    s_lshl_b32 s42, s30, 11
    s_add_u32 s42, s42, 262144
    s_lshl_b32 s30, s20, 9
    buffer_load_dwordx4 a[196:199], v60, s[4:7], s50 offen offset:256 sc1
    s_add_u32 s30, s30, 161792
    v_lshlrev_b32 v102, 4, v1
    v_add_u32 v32, 161792, v102
    v_lshl_add_u32 v102, v100, 8, v102
    v_add_u32 v102, s30, v102
    v_cmp_gt_u32 vcc, 48, v0
    buffer_load_dwordx4 a[200:203], v60, s[4:7], s50 offen offset:512 sc1
    s_add_u32 s50, s50, 196608
    v_mov_b32 v33, 2146435072
    v_cndmask_b32 v33, v33, v3, vcc
    s_mul_i32 s43, s21, 393216
    s_lshl_b32 s30, s22, 2
    s_add_u32 s30, s30, s20
    s_mul_i32 s30, s30, 768
    s_add_u32 s43, s43, s30
    buffer_load_dwordx4 a[204:207], v60, s[4:7], s50 offen offset:0 sc1
    s_add_u32 s43, s43, 20971520
    s_sub_u32 s30, s56, s20
    s_mul_i32 s46, s30, 49152
    s_mul_i32 s31, s20, 12288
    s_add_u32 s46, s46, s31
    s_add_u32 s46, s46, 20971520
    buffer_load_dwordx4 a[208:211], v60, s[4:7], s50 offen offset:256 sc1
    v_mul_u32_u24 v20, 336, v1
    v_lshl_add_u32 v20, v2, 4, v20
    s_mul_i32 s30, s20, 5376
    v_add_u32 v20, s30, v20
    s_lshl_b32 s30, s20, 2
    v_add_u32 v103, s30, v2
    v_subrev_u32 v104, 8, v1
    buffer_load_dwordx4 a[212:215], v60, s[4:7], s50 offen offset:512 sc1
    s_add_u32 s50, s50, 196608
    v_cmp_gt_u32 vcc, 10, v1
    s_nop 1
    v_cndmask_b32 v104, v104, v1, vcc
    v_mul_u32_u24 v21, 336, v103
    v_lshl_add_u32 v21, v104, 5, v21
    v_add_u32 v22, 140288, v21
    s_lshl_b32 s30, s26, 10
    buffer_load_dwordx4 a[216:219], v60, s[4:7], s50 offen offset:0 sc1
    s_add_u32 s30, s30, 161800
    v_lshl_add_u32 v23, v103, 4, s30
    v_mul_u32_u24 v25, 2560, v103
    v_lshl_add_u32 v25, v104, 4, v25
    v_cmp_gt_u32 vcc, 10, v1
    v_mov_b32 v103, 2146435072
    buffer_load_dwordx4 a[220:223], v60, s[4:7], s50 offen offset:256 sc1
    v_cndmask_b32 v25, v103, v25, vcc
    s_mul_i32 s30, s20, 40960
    s_sub_u32 s47, s53, s30
    s_mov_b32 s8, s78
    s_mov_b32 s9, s79
    s_mov_b32 s10, 2621440
    s_mov_b32 s11, 0x20000
    buffer_load_dwordx4 a[224:227], v60, s[4:7], s50 offen offset:512 sc1
    s_add_u32 s50, s50, 196608
    v_add_u32 v27, 32768, v53
    v_add_u32 v28, 32768, v54
    v_mov_b32 v29, s24
    s_lshl_b32 s30, s21, 2
    s_add_u32 s30, s30, s20
    s_lshl_b32 s30, s30, 9
    buffer_load_dwordx4 a[228:231], v60, s[4:7], s50 offen offset:0 sc1
    s_add_u32 s30, s30, 163840
    v_and_b32 v26, 3, v0
    v_lshl_add_u32 v26, v26, 7, s30
    v_mov_b32 v34, v61
    v_add_u32 v35, s41, v3
    s_mul_i32 s48, s20, 19456
    s_add_u32 s48, s48, 61440
    buffer_load_dwordx4 a[232:235], v60, s[4:7], s50 offen offset:256 sc1
    v_add_u32 v31, s48, v3
    s_add_u32 s32, s24, 1
    s_add_u32 s33, s24, 2
    s_add_u32 s34, s24, 3
    s_add_u32 s35, s24, 4
    v_mfma_f32_16x16x32_bf16 v[4:7], a[0:3], v[16:19], 0
    buffer_load_dwordx4 a[236:239], v60, s[4:7], s50 offen offset:512 sc1
    s_add_u32 s50, s50, 196608
    v_mfma_f32_16x16x32_bf16 v[8:11], a[4:7], v[16:19], 0
    v_mfma_f32_16x16x32_bf16 v[12:15], a[8:11], v[16:19], 0
    v_mfma_f32_16x16x32_bf16 v[4:7], a[12:15], v[16:19], v[4:7]
    v_mfma_f32_16x16x32_bf16 v[8:11], a[16:19], v[16:19], v[8:11]
    v_mfma_f32_16x16x32_bf16 v[12:15], a[20:23], v[16:19], v[12:15]
    v_mfma_f32_16x16x32_bf16 v[4:7], a[24:27], v[16:19], v[4:7]
    v_mfma_f32_16x16x32_bf16 v[8:11], a[28:31], v[16:19], v[8:11]
    buffer_load_dwordx4 v[132:135], v61, s[4:7], s52 offen offset:0 sc1
    v_mfma_f32_16x16x32_bf16 v[12:15], a[32:35], v[16:19], v[12:15]
    v_mfma_f32_16x16x32_bf16 v[4:7], a[36:39], v[16:19], v[4:7]
    v_mfma_f32_16x16x32_bf16 v[8:11], a[40:43], v[16:19], v[8:11]
    v_mfma_f32_16x16x32_bf16 v[12:15], a[44:47], v[16:19], v[12:15]
    v_mfma_f32_16x16x32_bf16 v[4:7], a[48:51], v[16:19], v[4:7]
    v_mfma_f32_16x16x32_bf16 v[8:11], a[52:55], v[16:19], v[8:11]
    buffer_load_dwordx4 v[136:139], v61, s[4:7], s52 offen offset:256 sc1
    v_mfma_f32_16x16x32_bf16 v[12:15], a[56:59], v[16:19], v[12:15]
    v_mfma_f32_16x16x32_bf16 v[4:7], a[60:63], v[16:19], v[4:7]
    v_mfma_f32_16x16x32_bf16 v[8:11], a[64:67], v[16:19], v[8:11]
    v_mfma_f32_16x16x32_bf16 v[12:15], a[68:71], v[16:19], v[12:15]
    v_mfma_f32_16x16x32_bf16 v[4:7], a[72:75], v[16:19], v[4:7]
    v_mfma_f32_16x16x32_bf16 v[8:11], a[76:79], v[16:19], v[8:11]
    buffer_load_dword v124, v56, s[4:7], s62 offen sc1
    v_mfma_f32_16x16x32_bf16 v[12:15], a[80:83], v[16:19], v[12:15]
    v_mfma_f32_16x16x32_bf16 v[4:7], a[84:87], v[16:19], v[4:7]
    v_mfma_f32_16x16x32_bf16 v[8:11], a[88:91], v[16:19], v[8:11]
    v_mfma_f32_16x16x32_bf16 v[12:15], a[92:95], v[16:19], v[12:15]
    v_mfma_f32_16x16x32_bf16 v[4:7], a[96:99], v[16:19], v[4:7]
    v_mfma_f32_16x16x32_bf16 v[8:11], a[100:103], v[16:19], v[8:11]
    v_mfma_f32_16x16x32_bf16 v[12:15], a[104:107], v[16:19], v[12:15]
    v_mfma_f32_16x16x32_bf16 v[4:7], a[108:111], v[16:19], v[4:7]
    v_mfma_f32_16x16x32_bf16 v[8:11], a[112:115], v[16:19], v[8:11]
    v_mfma_f32_16x16x32_bf16 v[12:15], a[116:119], v[16:19], v[12:15]
    v_mfma_f32_16x16x32_bf16 v[4:7], a[120:123], v[16:19], v[4:7]
    v_mfma_f32_16x16x32_bf16 v[8:11], a[124:127], v[16:19], v[8:11]
    v_mfma_f32_16x16x32_bf16 v[12:15], a[128:131], v[16:19], v[12:15]
    v_mfma_f32_16x16x32_bf16 v[4:7], a[132:135], v[16:19], v[4:7]
    v_mfma_f32_16x16x32_bf16 v[8:11], a[136:139], v[16:19], v[8:11]
    s_waitcnt vmcnt(0)
    v_cmp_ne_u32 vcc, s24, v124
    s_nop 0
    s_cbranch_vccnz L_g3
L_gx3:
    s_add_u32 s44, s40, 0
    s_add_u32 m0, s41, 0
    s_nop 0
    buffer_load_dwordx4 v3, s[4:7], s44 offen offset:0 sc1 lds
    buffer_load_dwordx4 v3, s[4:7], s44 offen offset:1024 sc1 lds
    buffer_load_dwordx4 v3, s[4:7], s44 offen offset:2048 sc1 lds
    buffer_load_dwordx4 v3, s[4:7], s44 offen offset:3072 sc1 lds
    s_add_u32 m0, s41, 4096
    s_nop 0
    buffer_load_dwordx4 v24, s[4:7], s44 offen offset:0 sc1 lds
    buffer_load_dword v36, v101, s[4:7], s42 offen offset:0 sc1
    buffer_load_dword v37, v101, s[4:7], s42 offen offset:128 sc1
    buffer_load_dword v38, v101, s[4:7], s42 offen offset:256 sc1
    buffer_load_dword v39, v101, s[4:7], s42 offen offset:384 sc1
    buffer_load_dword v40, v101, s[4:7], s42 offen offset:512 sc1
    buffer_load_dword v41, v101, s[4:7], s42 offen offset:640 sc1
    buffer_load_dword v42, v101, s[4:7], s42 offen offset:768 sc1
    buffer_load_dword v43, v101, s[4:7], s42 offen offset:896 sc1
    v_mov_b32 v63, v102
    v_mfma_f32_16x16x32_bf16 v[12:15], a[140:143], v[16:19], v[12:15]
    v_mfma_f32_16x16x32_bf16 v[4:7], a[144:147], v[16:19], v[4:7]
    v_mfma_f32_16x16x32_bf16 v[8:11], a[148:151], v[16:19], v[8:11]
    v_mfma_f32_16x16x32_bf16 v[12:15], a[152:155], v[16:19], v[12:15]
    v_mfma_f32_16x16x32_bf16 v[4:7], a[156:159], v[16:19], v[4:7]
    v_mfma_f32_16x16x32_bf16 v[8:11], a[160:163], v[16:19], v[8:11]
    v_mfma_f32_16x16x32_bf16 v[12:15], a[164:167], v[16:19], v[12:15]
    v_mfma_f32_16x16x32_bf16 v[4:7], a[168:171], v[16:19], v[4:7]
    v_mfma_f32_16x16x32_bf16 v[8:11], a[172:175], v[16:19], v[8:11]
    v_mfma_f32_16x16x32_bf16 v[12:15], a[176:179], v[16:19], v[12:15]
    v_mfma_f32_16x16x32_bf16 v[4:7], a[180:183], v[16:19], v[4:7]
    v_mfma_f32_16x16x32_bf16 v[8:11], a[184:187], v[16:19], v[8:11]
    v_mfma_f32_16x16x32_bf16 v[12:15], a[188:191], v[16:19], v[12:15]
    v_mfma_f32_16x16x32_bf16 v[4:7], a[192:195], v[16:19], v[4:7]
    v_mfma_f32_16x16x32_bf16 v[8:11], a[196:199], v[16:19], v[8:11]
    v_mfma_f32_16x16x32_bf16 v[12:15], a[200:203], v[16:19], v[12:15]
    v_mfma_f32_16x16x32_bf16 v[4:7], a[204:207], v[16:19], v[4:7]
    v_mfma_f32_16x16x32_bf16 v[8:11], a[208:211], v[16:19], v[8:11]
    v_mfma_f32_16x16x32_bf16 v[12:15], a[212:215], v[16:19], v[12:15]
    v_mfma_f32_16x16x32_bf16 v[4:7], a[216:219], v[16:19], v[4:7]
    v_mfma_f32_16x16x32_bf16 v[8:11], a[220:223], v[16:19], v[8:11]
    v_mfma_f32_16x16x32_bf16 v[12:15], a[224:227], v[16:19], v[12:15]
    v_mfma_f32_16x16x32_bf16 v[4:7], a[228:231], v[16:19], v[4:7]
    v_mfma_f32_16x16x32_bf16 v[8:11], a[232:235], v[16:19], v[8:11]
    v_mfma_f32_16x16x32_bf16 v[12:15], a[236:239], v[16:19], v[12:15]
    s_waitcnt vmcnt(8)
    s_barrier
    ds_read_b128 v[88:91], v3 offset:0
    ds_read_b128 v[92:95], v3 offset:1024
    ds_read_b128 v[96:99], v3 offset:2048
    ds_read_b128 v[100:103], v3 offset:3072
    ds_read_b128 v[104:107], v3 offset:4096
    s_waitcnt lgkmcnt(4)
    v_mfma_f32_16x16x32_bf16 v[64:67], a[0:3], v[88:91], 0
    s_add_u32 s44, s40, 81920
    s_add_u32 m0, s41, 20480
    ds_read_b128 v[108:111], v3 offset:5120
    s_waitcnt lgkmcnt(4)
    v_mfma_f32_16x16x32_bf16 v[64:67], a[12:15], v[92:95], v[64:67]
    ds_read_b128 v[112:115], v3 offset:6144
    s_waitcnt lgkmcnt(4)
    v_mfma_f32_16x16x32_bf16 v[64:67], a[24:27], v[96:99], v[64:67]
    buffer_load_dwordx4 v3, s[4:7], s44 offen offset:0 sc1 lds
    s_waitcnt lgkmcnt(3)
    v_mfma_f32_16x16x32_bf16 v[64:67], a[36:39], v[100:103], v[64:67]
    s_add_u32 m0, s41, 20480
    ds_read_b128 v[116:119], v3 offset:7168
    s_waitcnt lgkmcnt(3)
    v_mfma_f32_16x16x32_bf16 v[64:67], a[48:51], v[104:107], v[64:67]
    ds_read_b128 v[120:123], v3 offset:8192
    v_mfma_f32_16x16x32_bf16 v[68:71], a[4:7], v[88:91], 0
    buffer_load_dwordx4 v3, s[4:7], s44 offen offset:1024 sc1 lds
    v_mfma_f32_16x16x32_bf16 v[68:71], a[16:19], v[92:95], v[68:71]
    s_add_u32 m0, s41, 20480
    ds_read_b128 v[124:127], v3 offset:9216
    v_mfma_f32_16x16x32_bf16 v[68:71], a[28:31], v[96:99], v[68:71]
    buffer_load_dwordx4 v3, s[4:7], s44 offen offset:2048 sc1 lds
    v_mfma_f32_16x16x32_bf16 v[68:71], a[40:43], v[100:103], v[68:71]
    s_add_u32 m0, s41, 20480
    v_mfma_f32_16x16x32_bf16 v[68:71], a[52:55], v[104:107], v[68:71]
    buffer_load_dwordx4 v3, s[4:7], s44 offen offset:3072 sc1 lds
    v_mfma_f32_16x16x32_bf16 v[72:75], a[8:11], v[88:91], 0
    s_add_u32 m0, s41, 24576
    v_mfma_f32_16x16x32_bf16 v[72:75], a[20:23], v[92:95], v[72:75]
    v_mfma_f32_16x16x32_bf16 v[72:75], a[32:35], v[96:99], v[72:75]
    buffer_load_dwordx4 v24, s[4:7], s44 offen offset:0 sc1 lds
    v_mfma_f32_16x16x32_bf16 v[72:75], a[44:47], v[100:103], v[72:75]
    s_add_u32 s44, s40, 20480
    s_add_u32 m0, s41, 40960
    s_waitcnt vmcnt(5)
    v_mfma_f32_16x16x32_bf16 v[72:75], a[56:59], v[104:107], v[72:75]
    s_waitcnt lgkmcnt(0)
    v_add_f32 v36, v36, v37
    v_add_f32 v36, v36, v38
    v_mfma_f32_16x16x32_bf16 v[64:67], a[60:63], v[108:111], v[64:67]
    ds_read_b128 v[88:91], v3 offset:10240
    v_add_f32 v36, v36, v39
    v_mfma_f32_16x16x32_bf16 v[64:67], a[72:75], v[112:115], v[64:67]
    ds_read_b128 v[92:95], v3 offset:11264
    v_add_f32 v36, v36, v40
    v_mfma_f32_16x16x32_bf16 v[64:67], a[84:87], v[116:119], v[64:67]
    buffer_load_dwordx4 v3, s[4:7], s44 offen offset:0 sc1 lds
    v_mfma_f32_16x16x32_bf16 v[64:67], a[96:99], v[120:123], v[64:67]
    s_add_u32 m0, s41, 40960
    ds_read_b128 v[96:99], v3 offset:12288
    v_add_f32 v36, v36, v41
    v_mfma_f32_16x16x32_bf16 v[64:67], a[108:111], v[124:127], v[64:67]
    ds_read_b128 v[100:103], v3 offset:13312
    v_add_f32 v36, v36, v42
    v_mfma_f32_16x16x32_bf16 v[68:71], a[64:67], v[108:111], v[68:71]
    buffer_load_dwordx4 v3, s[4:7], s44 offen offset:1024 sc1 lds
    v_mfma_f32_16x16x32_bf16 v[68:71], a[76:79], v[112:115], v[68:71]
    s_add_u32 m0, s41, 40960
    ds_read_b128 v[104:107], v3 offset:14336
    v_add_f32 v36, v36, v43
    v_mfma_f32_16x16x32_bf16 v[68:71], a[88:91], v[116:119], v[68:71]
    v_mul_f32 v37, 0x3acccccd, v36
    v_mfma_f32_16x16x32_bf16 v[68:71], a[100:103], v[120:123], v[68:71]
    buffer_load_dwordx4 v3, s[4:7], s44 offen offset:2048 sc1 lds
    v_mfma_f32_16x16x32_bf16 v[68:71], a[112:115], v[124:127], v[68:71]
    v_mul_f32 v36, 0x3acccccd, v36
    v_mfma_f32_16x16x32_bf16 v[72:75], a[68:71], v[108:111], v[72:75]
    s_nop 0
    v_permlane16_swap_b32 v36, v37
    v_mfma_f32_16x16x32_bf16 v[72:75], a[80:83], v[112:115], v[72:75]
    s_add_u32 m0, s41, 40960
    v_mfma_f32_16x16x32_bf16 v[72:75], a[92:95], v[116:119], v[72:75]
    v_mfma_f32_16x16x32_bf16 v[72:75], a[104:107], v[120:123], v[72:75]
    buffer_load_dwordx4 v3, s[4:7], s44 offen offset:3072 sc1 lds
    v_mfma_f32_16x16x32_bf16 v[72:75], a[116:119], v[124:127], v[72:75]
    s_waitcnt lgkmcnt(0)
    v_fma_f32 v37, -v36, v36, v37
    v_max_f32 v37, 0, v37
    v_mfma_f32_16x16x32_bf16 v[64:67], a[120:123], v[88:91], v[64:67]
    s_add_u32 m0, s41, 45056
    ds_read_b128 v[108:111], v3 offset:15360
    v_mfma_f32_16x16x32_bf16 v[64:67], a[132:135], v[92:95], v[64:67]
    ds_read_b128 v[112:115], v3 offset:16384
    v_add_f32 v37, 0x3727c5ac, v37
    v_mfma_f32_16x16x32_bf16 v[64:67], a[144:147], v[96:99], v[64:67]
    buffer_load_dwordx4 v24, s[4:7], s44 offen offset:0 sc1 lds
    v_mfma_f32_16x16x32_bf16 v[64:67], a[156:159], v[100:103], v[64:67]
    ds_read_b128 v[116:119], v3 offset:17408
    v_mfma_f32_16x16x32_bf16 v[64:67], a[168:171], v[104:107], v[64:67]
    ds_read_b128 v[120:123], v3 offset:18432
    v_mfma_f32_16x16x32_bf16 v[68:71], a[124:127], v[88:91], v[68:71]
    v_rsq_f32 v39, v37
    v_mfma_f32_16x16x32_bf16 v[68:71], a[136:139], v[92:95], v[68:71]
    ds_read_b128 v[124:127], v3 offset:19456
    v_sub_f32 v36, 0, v36
    v_mfma_f32_16x16x32_bf16 v[68:71], a[148:151], v[96:99], v[68:71]
    buffer_load_dwordx4 v[140:143], v34, s[4:7], s52 offen offset:512 sc1
    v_mfma_f32_16x16x32_bf16 v[68:71], a[160:163], v[100:103], v[68:71]
    v_mul_f32 v37, 0xbfb8aa3b, v39
    v_mul_f32 v38, v39, v39
    v_mfma_f32_16x16x32_bf16 v[68:71], a[172:175], v[104:107], v[68:71]
L_hop3:
    s_cbranch_execz L_hopret
    v_mfma_f32_16x16x32_bf16 v[72:75], a[128:131], v[88:91], v[72:75]
    ds_write_b128 v63, v[36:39]
    v_mfma_f32_16x16x32_bf16 v[72:75], a[140:143], v[92:95], v[72:75]
    buffer_load_dwordx4 v[144:147], v34, s[4:7], s52 offen offset:768 sc1
    v_mfma_f32_16x16x32_bf16 v[72:75], a[152:155], v[96:99], v[72:75]
    v_mfma_f32_16x16x32_bf16 v[72:75], a[164:167], v[100:103], v[72:75]
    v_mfma_f32_16x16x32_bf16 v[72:75], a[176:179], v[104:107], v[72:75]
    s_waitcnt lgkmcnt(1)
    v_mfma_f32_16x16x32_bf16 v[64:67], a[180:183], v[108:111], v[64:67]
    s_waitcnt vmcnt(7) lgkmcnt(0)
    s_barrier
    v_mfma_f32_16x16x32_bf16 v[64:67], a[192:195], v[112:115], v[64:67]
    ds_read_b128 v[88:91], v3 offset:20480
    v_mfma_f32_16x16x32_bf16 v[64:67], a[204:207], v[116:119], v[64:67]
    buffer_load_dwordx4 v[148:151], v34, s[4:7], s52 offen offset:1024 sc1
    v_mfma_f32_16x16x32_bf16 v[64:67], a[216:219], v[120:123], v[64:67]
    s_add_u32 s52, s52, 40960
    ds_read_b128 v[92:95], v3 offset:21504
    v_mfma_f32_16x16x32_bf16 v[64:67], a[228:231], v[124:127], v[64:67]
    ds_read_b128 v[96:99], v3 offset:22528
    v_mfma_f32_16x16x32_bf16 v[68:71], a[184:187], v[108:111], v[68:71]
    buffer_load_dwordx4 v[152:155], v34, s[4:7], s52 offen offset:0 sc1
    v_mfma_f32_16x16x32_bf16 v[68:71], a[196:199], v[112:115], v[68:71]
    ds_read_b128 v[100:103], v3 offset:23552
    v_mfma_f32_16x16x32_bf16 v[68:71], a[208:211], v[116:119], v[68:71]
    ds_read_b64 v[56:57], v32 offset:0
    v_mfma_f32_16x16x32_bf16 v[68:71], a[220:223], v[120:123], v[68:71]
    ds_read_b128 v[104:107], v3 offset:24576
    v_mfma_f32_16x16x32_bf16 v[68:71], a[232:235], v[124:127], v[68:71]
    buffer_load_dwordx4 v[156:159], v34, s[4:7], s52 offen offset:256 sc1
    v_mfma_f32_16x16x32_bf16 v[72:75], a[188:191], v[108:111], v[72:75]
    v_mfma_f32_16x16x32_bf16 v[72:75], a[200:203], v[112:115], v[72:75]
    s_add_u32 s44, s40, 102400
    s_add_u32 m0, s41, 0
    v_mfma_f32_16x16x32_bf16 v[72:75], a[212:215], v[116:119], v[72:75]
    v_mfma_f32_16x16x32_bf16 v[72:75], a[224:227], v[120:123], v[72:75]
    buffer_load_dwordx4 v3, s[4:7], s44 offen offset:0 sc1 lds
    v_mfma_f32_16x16x32_bf16 v[72:75], a[236:239], v[124:127], v[72:75]
    s_waitcnt lgkmcnt(0)
    v_mfma_f32_16x16x32_bf16 v[76:79], a[0:3], v[88:91], 0
    ds_read_b128 v[108:111], v3 offset:25600
    v_mfma_f32_16x16x32_bf16 v[76:79], a[12:15], v[92:95], v[76:79]
    s_add_u32 m0, s41, 0
    ds_read_b128 v[112:115], v3 offset:26624
    v_mfma_f32_16x16x32_bf16 v[76:79], a[24:27], v[96:99], v[76:79]
    v_fmac_f32 v64, v56, v4
    v_fmac_f32 v65, v56, v5
    v_mfma_f32_16x16x32_bf16 v[76:79], a[36:39], v[100:103], v[76:79]
    ds_read_b128 v[116:119], v3 offset:27648
    v_fmac_f32 v68, v56, v8
    v_mfma_f32_16x16x32_bf16 v[76:79], a[48:51], v[104:107], v[76:79]
    ds_read_b128 v[120:123], v3 offset:28672
    v_fmac_f32 v69, v56, v9
    v_mfma_f32_16x16x32_bf16 v[80:83], a[4:7], v[88:91], 0
    buffer_load_dwordx4 v3, s[4:7], s44 offen offset:1024 sc1 lds
    v_mfma_f32_16x16x32_bf16 v[80:83], a[16:19], v[92:95], v[80:83]
    s_add_u32 m0, s41, 0
    ds_read_b128 v[124:127], v3 offset:29696
    v_fmac_f32 v72, v56, v12
    v_mfma_f32_16x16x32_bf16 v[80:83], a[28:31], v[96:99], v[80:83]
    buffer_load_dwordx4 v3, s[4:7], s44 offen offset:2048 sc1 lds
    v_mfma_f32_16x16x32_bf16 v[80:83], a[40:43], v[100:103], v[80:83]
    v_fmac_f32 v73, v56, v13
    v_mul_f32 v36, v57, v64
    v_mfma_f32_16x16x32_bf16 v[80:83], a[52:55], v[104:107], v[80:83]
    v_mul_f32 v37, v57, v65
    v_mul_f32 v38, v57, v68
    v_mfma_f32_16x16x32_bf16 v[84:87], a[8:11], v[88:91], 0
    s_add_u32 m0, s41, 0
    v_mul_f32 v39, v57, v69
    v_mul_f32 v40, v57, v72
    v_mfma_f32_16x16x32_bf16 v[84:87], a[20:23], v[92:95], v[84:87]
    v_mul_f32 v41, v57, v73
    v_mfma_f32_16x16x32_bf16 v[84:87], a[32:35], v[96:99], v[84:87]
    buffer_load_dwordx4 v3, s[4:7], s44 offen offset:3072 sc1 lds
    v_mfma_f32_16x16x32_bf16 v[84:87], a[44:47], v[100:103], v[84:87]
    v_exp_f32 v36, v36
    v_mfma_f32_16x16x32_bf16 v[84:87], a[56:59], v[104:107], v[84:87]
    s_waitcnt lgkmcnt(0)
    s_add_u32 m0, s41, 4096
    v_mfma_f32_16x16x32_bf16 v[76:79], a[60:63], v[108:111], v[76:79]
    ds_read_b128 v[88:91], v3 offset:30720
    v_exp_f32 v37, v37
    v_mfma_f32_16x16x32_bf16 v[76:79], a[72:75], v[112:115], v[76:79]
    ds_read_b128 v[92:95], v3 offset:31744
    v_mfma_f32_16x16x32_bf16 v[76:79], a[84:87], v[116:119], v[76:79]
    buffer_load_dwordx4 v24, s[4:7], s44 offen offset:0 sc1 lds
    v_mfma_f32_16x16x32_bf16 v[76:79], a[96:99], v[120:123], v[76:79]
    ds_read_b128 v[96:99], v3 offset:32768
    v_exp_f32 v38, v38
    v_mfma_f32_16x16x32_bf16 v[76:79], a[108:111], v[124:127], v[76:79]
    ds_read_b128 v[100:103], v3 offset:33792
    v_exp_f32 v39, v39
    v_mfma_f32_16x16x32_bf16 v[80:83], a[64:67], v[108:111], v[80:83]
    v_exp_f32 v40, v40
    v_mfma_f32_16x16x32_bf16 v[80:83], a[76:79], v[112:115], v[80:83]
    ds_read_b128 v[104:107], v3 offset:34816
    v_exp_f32 v41, v41
    v_mfma_f32_16x16x32_bf16 v[80:83], a[88:91], v[116:119], v[80:83]
    buffer_load_dwordx4 v[160:163], v34, s[4:7], s52 offen offset:512 sc1
    v_mfma_f32_16x16x32_bf16 v[80:83], a[100:103], v[120:123], v[80:83]
    v_fmac_f32 v66, v56, v6
    v_fmac_f32 v67, v56, v7
    v_mfma_f32_16x16x32_bf16 v[80:83], a[112:115], v[124:127], v[80:83]
    v_fmac_f32 v70, v56, v10
    v_fmac_f32 v71, v56, v11
    v_mfma_f32_16x16x32_bf16 v[84:87], a[68:71], v[108:111], v[84:87]
    buffer_load_dwordx4 v[164:167], v34, s[4:7], s52 offen offset:768 sc1
    v_mfma_f32_16x16x32_bf16 v[84:87], a[80:83], v[112:115], v[84:87]
    v_fmac_f32 v74, v56, v14
    v_fmac_f32 v75, v56, v15
    v_mfma_f32_16x16x32_bf16 v[84:87], a[92:95], v[116:119], v[84:87]
    v_mul_f32 v42, v64, v66
    v_mul_f32 v43, v65, v67
    v_mfma_f32_16x16x32_bf16 v[84:87], a[104:107], v[120:123], v[84:87]
    v_mul_f32 v44, v68, v70
    v_mul_f32 v45, v69, v71
    v_mfma_f32_16x16x32_bf16 v[84:87], a[116:119], v[124:127], v[84:87]
    s_waitcnt lgkmcnt(0)
    v_mul_f32 v46, v72, v74
    v_mul_f32 v47, v73, v75
    v_mfma_f32_16x16x32_bf16 v[76:79], a[120:123], v[88:91], v[76:79]
    ds_read_b128 v[108:111], v3 offset:35840
    v_add_f32 v36, 1.0, v36
    v_mfma_f32_16x16x32_bf16 v[76:79], a[132:135], v[92:95], v[76:79]
    ds_read_b128 v[112:115], v3 offset:36864
    v_add_f32 v37, 1.0, v37
    v_mfma_f32_16x16x32_bf16 v[76:79], a[144:147], v[96:99], v[76:79]
    buffer_load_dwordx4 v[168:171], v34, s[4:7], s52 offen offset:1024 sc1
    v_mfma_f32_16x16x32_bf16 v[76:79], a[156:159], v[100:103], v[76:79]
    s_add_u32 s52, s52, 40960
    ds_read_b128 v[116:119], v3 offset:37888
    v_add_f32 v38, 1.0, v38
    v_mfma_f32_16x16x32_bf16 v[76:79], a[168:171], v[104:107], v[76:79]
    ds_read_b128 v[120:123], v3 offset:38912
    v_add_f32 v39, 1.0, v39
    v_mfma_f32_16x16x32_bf16 v[80:83], a[124:127], v[88:91], v[80:83]
    buffer_load_dwordx4 v[172:175], v34, s[4:7], s52 offen offset:0 sc1
    v_add_f32 v40, 1.0, v40
    v_mfma_f32_16x16x32_bf16 v[80:83], a[136:139], v[92:95], v[80:83]
    ds_read_b128 v[124:127], v3 offset:39936
    v_add_f32 v41, 1.0, v41
    v_mfma_f32_16x16x32_bf16 v[80:83], a[148:151], v[96:99], v[80:83]
    v_rcp_f32 v36, v36
    v_mfma_f32_16x16x32_bf16 v[80:83], a[160:163], v[100:103], v[80:83]
    buffer_load_dwordx4 v[176:179], v34, s[4:7], s52 offen offset:256 sc1
    v_mfma_f32_16x16x32_bf16 v[80:83], a[172:175], v[104:107], v[80:83]
    v_rcp_f32 v37, v37
    v_mfma_f32_16x16x32_bf16 v[84:87], a[128:131], v[88:91], v[84:87]
    v_rcp_f32 v38, v38
    v_mfma_f32_16x16x32_bf16 v[84:87], a[140:143], v[92:95], v[84:87]
    v_rcp_f32 v39, v39
    v_mfma_f32_16x16x32_bf16 v[84:87], a[152:155], v[96:99], v[84:87]
    v_rcp_f32 v40, v40
    v_mfma_f32_16x16x32_bf16 v[84:87], a[164:167], v[100:103], v[84:87]
    buffer_load_dwordx4 v[180:183], v34, s[4:7], s52 offen offset:512 sc1
    v_mfma_f32_16x16x32_bf16 v[84:87], a[176:179], v[104:107], v[84:87]
    s_waitcnt lgkmcnt(0)
    v_rcp_f32 v41, v41
    v_mfma_f32_16x16x32_bf16 v[76:79], a[180:183], v[108:111], v[76:79]
    s_waitcnt vmcnt(16)
    s_barrier
    v_mfma_f32_16x16x32_bf16 v[76:79], a[192:195], v[112:115], v[76:79]
    ds_read_b128 v[88:91], v3 offset:40960
    v_mul_f32 v42, v42, v36
    v_mfma_f32_16x16x32_bf16 v[76:79], a[204:207], v[116:119], v[76:79]
    buffer_load_dwordx4 v[184:187], v34, s[4:7], s52 offen offset:768 sc1
    v_mul_f32 v43, v43, v37
    v_mfma_f32_16x16x32_bf16 v[76:79], a[216:219], v[120:123], v[76:79]
    ds_read_b128 v[92:95], v3 offset:41984
    v_mul_f32 v44, v44, v38
    v_mfma_f32_16x16x32_bf16 v[76:79], a[228:231], v[124:127], v[76:79]
    ds_read_b128 v[96:99], v3 offset:43008
    v_mul_f32 v45, v45, v39
    v_mul_f32 v46, v46, v40
    v_mfma_f32_16x16x32_bf16 v[80:83], a[184:187], v[108:111], v[80:83]
    v_mul_f32 v47, v47, v41
    v_cvt_pk_bf16_f32 v48, v42, v43
    v_mfma_f32_16x16x32_bf16 v[80:83], a[196:199], v[112:115], v[80:83]
    ds_read_b128 v[100:103], v3 offset:44032
    ds_read_b64 v[56:57], v32 offset:1024
    v_mfma_f32_16x16x32_bf16 v[80:83], a[208:211], v[116:119], v[80:83]
    buffer_load_dwordx4 v[188:191], v34, s[4:7], s52 offen offset:1024 sc1
    v_mfma_f32_16x16x32_bf16 v[80:83], a[220:223], v[120:123], v[80:83]
    s_add_u32 s52, s52, 40960
    ds_read_b128 v[104:107], v3 offset:45056
    v_cvt_pk_bf16_f32 v50, v46, v47
    v_cvt_pk_bf16_f32 v49, v44, v45
    v_mfma_f32_16x16x32_bf16 v[80:83], a[232:235], v[124:127], v[80:83]
    s_add_u32 s44, s40, 40960
    s_add_u32 m0, s41, 20480
    s_add_u32 s45, s43, 0
    v_mfma_f32_16x16x32_bf16 v[84:87], a[188:191], v[108:111], v[84:87]
    v_permlane32_swap_b32 v48, v50
    v_mfma_f32_16x16x32_bf16 v[84:87], a[200:203], v[112:115], v[84:87]
    v_permlane32_swap_b32 v49, v51
    v_mfma_f32_16x16x32_bf16 v[84:87], a[212:215], v[116:119], v[84:87]
    buffer_load_dwordx4 v3, s[4:7], s44 offen offset:0 sc1 lds
    v_mfma_f32_16x16x32_bf16 v[84:87], a[224:227], v[120:123], v[84:87]
    s_add_u32 m0, s41, 20480
    v_permlane16_swap_b32 v48, v49
    v_mfma_f32_16x16x32_bf16 v[84:87], a[236:239], v[124:127], v[84:87]
    s_waitcnt lgkmcnt(0)
    v_permlane16_swap_b32 v50, v51
    v_mfma_f32_16x16x32_bf16 v[64:67], a[0:3], v[88:91], 0
    ds_read_b128 v[108:111], v3 offset:46080
    v_mfma_f32_16x16x32_bf16 v[64:67], a[12:15], v[92:95], v[64:67]
    ds_read_b128 v[112:115], v3 offset:47104
    v_mfma_f32_16x16x32_bf16 v[64:67], a[24:27], v[96:99], v[64:67]
    buffer_load_dwordx4 v3, s[4:7], s44 offen offset:1024 sc1 lds
    v_mfma_f32_16x16x32_bf16 v[64:67], a[36:39], v[100:103], v[64:67]
    s_add_u32 m0, s41, 20480
    ds_read_b128 v[116:119], v3 offset:48128
    v_mfma_f32_16x16x32_bf16 v[64:67], a[48:51], v[104:107], v[64:67]
    ds_read_b128 v[120:123], v3 offset:49152
    v_mfma_f32_16x16x32_bf16 v[68:71], a[4:7], v[88:91], 0
    buffer_store_dwordx4 v[48:51], v33, s[4:7], s45 offen sc1
    v_mfma_f32_16x16x32_bf16 v[68:71], a[16:19], v[92:95], v[68:71]
    ds_read_b128 v[124:127], v3 offset:50176
    v_fmac_f32 v76, v56, v4
    v_fmac_f32 v77, v56, v5
    v_mfma_f32_16x16x32_bf16 v[68:71], a[28:31], v[96:99], v[68:71]
    buffer_load_dwordx4 v3, s[4:7], s44 offen offset:2048 sc1 lds
    v_fmac_f32 v80, v56, v8
    v_mfma_f32_16x16x32_bf16 v[68:71], a[40:43], v[100:103], v[68:71]
    s_add_u32 m0, s41, 20480
    v_fmac_f32 v81, v56, v9
    v_fmac_f32 v84, v56, v12
    v_fmac_f32 v85, v56, v13
    v_mfma_f32_16x16x32_bf16 v[68:71], a[52:55], v[104:107], v[68:71]
    v_mul_f32 v36, v57, v76
    v_mul_f32 v37, v57, v77
    v_mfma_f32_16x16x32_bf16 v[72:75], a[8:11], v[88:91], 0
    buffer_load_dwordx4 v3, s[4:7], s44 offen offset:3072 sc1 lds
    v_mul_f32 v38, v57, v80
    v_mfma_f32_16x16x32_bf16 v[72:75], a[20:23], v[92:95], v[72:75]
    s_add_u32 m0, s41, 24576
    v_mul_f32 v39, v57, v81
    v_mul_f32 v40, v57, v84
    v_mfma_f32_16x16x32_bf16 v[72:75], a[32:35], v[96:99], v[72:75]
    v_mul_f32 v41, v57, v85
    v_mfma_f32_16x16x32_bf16 v[72:75], a[44:47], v[100:103], v[72:75]
    buffer_load_dwordx4 v24, s[4:7], s44 offen offset:0 sc1 lds
    v_mfma_f32_16x16x32_bf16 v[72:75], a[56:59], v[104:107], v[72:75]
    s_waitcnt lgkmcnt(0)
    v_exp_f32 v36, v36
    v_mfma_f32_16x16x32_bf16 v[64:67], a[60:63], v[108:111], v[64:67]
    ds_read_b128 v[88:91], v3 offset:51200
    v_exp_f32 v37, v37
    v_mfma_f32_16x16x32_bf16 v[64:67], a[72:75], v[112:115], v[64:67]
    ds_read_b128 v[92:95], v3 offset:52224
    v_mfma_f32_16x16x32_bf16 v[64:67], a[84:87], v[116:119], v[64:67]
    v_exp_f32 v38, v38
    v_mfma_f32_16x16x32_bf16 v[64:67], a[96:99], v[120:123], v[64:67]
    ds_read_b128 v[96:99], v3 offset:53248
    v_exp_f32 v39, v39
    v_mfma_f32_16x16x32_bf16 v[64:67], a[108:111], v[124:127], v[64:67]
    ds_read_b128 v[100:103], v3 offset:54272
    v_mfma_f32_16x16x32_bf16 v[68:71], a[64:67], v[108:111], v[68:71]
    buffer_load_dwordx4 v[192:195], v34, s[4:7], s52 offen offset:0 sc1
    v_mfma_f32_16x16x32_bf16 v[68:71], a[76:79], v[112:115], v[68:71]
    ds_read_b128 v[104:107], v3 offset:55296
    v_exp_f32 v40, v40
    v_mfma_f32_16x16x32_bf16 v[68:71], a[88:91], v[116:119], v[68:71]
    v_exp_f32 v41, v41
    v_mfma_f32_16x16x32_bf16 v[68:71], a[100:103], v[120:123], v[68:71]
    buffer_load_dwordx4 v[196:199], v34, s[4:7], s52 offen offset:256 sc1
    v_fmac_f32 v78, v56, v6
    v_mfma_f32_16x16x32_bf16 v[68:71], a[112:115], v[124:127], v[68:71]
    v_fmac_f32 v79, v56, v7
    v_fmac_f32 v82, v56, v10
    v_mfma_f32_16x16x32_bf16 v[72:75], a[68:71], v[108:111], v[72:75]
    v_fmac_f32 v83, v56, v11
    v_fmac_f32 v86, v56, v14
    v_mfma_f32_16x16x32_bf16 v[72:75], a[80:83], v[112:115], v[72:75]
    v_fmac_f32 v87, v56, v15
    v_mul_f32 v42, v76, v78
    v_mfma_f32_16x16x32_bf16 v[72:75], a[92:95], v[116:119], v[72:75]
    buffer_load_dwordx4 v[200:203], v34, s[4:7], s52 offen offset:512 sc1
    v_mfma_f32_16x16x32_bf16 v[72:75], a[104:107], v[120:123], v[72:75]
    v_mul_f32 v43, v77, v79
    v_mul_f32 v44, v80, v82
    v_mfma_f32_16x16x32_bf16 v[72:75], a[116:119], v[124:127], v[72:75]
    s_waitcnt lgkmcnt(0)
    v_mul_f32 v45, v81, v83
    v_mul_f32 v46, v84, v86
    v_mfma_f32_16x16x32_bf16 v[64:67], a[120:123], v[88:91], v[64:67]
    ds_read_b128 v[108:111], v3 offset:56320
    v_mul_f32 v47, v85, v87
    v_mfma_f32_16x16x32_bf16 v[64:67], a[132:135], v[92:95], v[64:67]
    ds_read_b128 v[112:115], v3 offset:57344
    v_add_f32 v36, 1.0, v36
    v_mfma_f32_16x16x32_bf16 v[64:67], a[144:147], v[96:99], v[64:67]
    buffer_load_dwordx4 v[204:207], v34, s[4:7], s52 offen offset:768 sc1
    v_mfma_f32_16x16x32_bf16 v[64:67], a[156:159], v[100:103], v[64:67]
    ds_read_b128 v[116:119], v3 offset:58368
    v_add_f32 v37, 1.0, v37
    v_mfma_f32_16x16x32_bf16 v[64:67], a[168:171], v[104:107], v[64:67]
    ds_read_b128 v[120:123], v3 offset:59392
    v_add_f32 v38, 1.0, v38
    v_mfma_f32_16x16x32_bf16 v[68:71], a[124:127], v[88:91], v[68:71]
    v_add_f32 v39, 1.0, v39
    v_add_f32 v40, 1.0, v40
    v_mfma_f32_16x16x32_bf16 v[68:71], a[136:139], v[92:95], v[68:71]
    ds_read_b128 v[124:127], v3 offset:60416
    v_add_f32 v41, 1.0, v41
    v_mfma_f32_16x16x32_bf16 v[68:71], a[148:151], v[96:99], v[68:71]
    buffer_load_dwordx4 v[208:211], v34, s[4:7], s52 offen offset:1024 sc1
    v_mfma_f32_16x16x32_bf16 v[68:71], a[160:163], v[100:103], v[68:71]
    s_add_u32 s52, s52, 40960
    v_rcp_f32 v36, v36
    v_mfma_f32_16x16x32_bf16 v[68:71], a[172:175], v[104:107], v[68:71]
    v_rcp_f32 v37, v37
    v_mfma_f32_16x16x32_bf16 v[72:75], a[128:131], v[88:91], v[72:75]
    buffer_load_dwordx4 v[212:215], v34, s[4:7], s52 offen offset:0 sc1
    v_mfma_f32_16x16x32_bf16 v[72:75], a[140:143], v[92:95], v[72:75]
    v_rcp_f32 v38, v38
    v_mfma_f32_16x16x32_bf16 v[72:75], a[152:155], v[96:99], v[72:75]
    v_rcp_f32 v39, v39
    v_mfma_f32_16x16x32_bf16 v[72:75], a[164:167], v[100:103], v[72:75]
    v_rcp_f32 v40, v40
    v_mfma_f32_16x16x32_bf16 v[72:75], a[176:179], v[104:107], v[72:75]
    s_waitcnt lgkmcnt(0)
    v_rcp_f32 v41, v41
    v_mfma_f32_16x16x32_bf16 v[64:67], a[180:183], v[108:111], v[64:67]
    s_waitcnt vmcnt(20)
    s_barrier
    v_mfma_f32_16x16x32_bf16 v[64:67], a[192:195], v[112:115], v[64:67]
    ds_read_b128 v[88:91], v3 offset:0
    v_mul_f32 v42, v42, v36
    v_mfma_f32_16x16x32_bf16 v[64:67], a[204:207], v[116:119], v[64:67]
    buffer_load_dwordx4 v[216:219], v34, s[4:7], s52 offen offset:256 sc1
    v_mul_f32 v43, v43, v37
    v_mfma_f32_16x16x32_bf16 v[64:67], a[216:219], v[120:123], v[64:67]
    ds_read_b128 v[92:95], v3 offset:1024
    v_mul_f32 v44, v44, v38
    v_mfma_f32_16x16x32_bf16 v[64:67], a[228:231], v[124:127], v[64:67]
    ds_read_b128 v[96:99], v3 offset:2048
    v_mul_f32 v45, v45, v39
    v_mul_f32 v46, v46, v40
    v_mfma_f32_16x16x32_bf16 v[68:71], a[184:187], v[108:111], v[68:71]
    buffer_load_dwordx4 v[220:223], v34, s[4:7], s52 offen offset:512 sc1
    v_mul_f32 v47, v47, v41
    v_mfma_f32_16x16x32_bf16 v[68:71], a[196:199], v[112:115], v[68:71]
    ds_read_b128 v[100:103], v3 offset:3072
    v_cvt_pk_bf16_f32 v48, v42, v43
    v_mfma_f32_16x16x32_bf16 v[68:71], a[208:211], v[116:119], v[68:71]
    ds_read_b64 v[56:57], v32 offset:256
    v_cvt_pk_bf16_f32 v50, v46, v47
    v_mfma_f32_16x16x32_bf16 v[68:71], a[220:223], v[120:123], v[68:71]
    ds_read_b128 v[104:107], v3 offset:4096
    v_cvt_pk_bf16_f32 v49, v44, v45
    v_mfma_f32_16x16x32_bf16 v[68:71], a[232:235], v[124:127], v[68:71]
    s_add_u32 s45, s43, 196608
    buffer_load_dwordx4 v[224:227], v34, s[4:7], s52 offen offset:768 sc1
    v_mfma_f32_16x16x32_bf16 v[72:75], a[188:191], v[108:111], v[72:75]
    s_add_u32 s44, s40, 122880
    v_permlane32_swap_b32 v48, v50
    v_mfma_f32_16x16x32_bf16 v[72:75], a[200:203], v[112:115], v[72:75]
    s_add_u32 m0, s41, 40960
    v_permlane32_swap_b32 v49, v51
    v_mfma_f32_16x16x32_bf16 v[72:75], a[212:215], v[116:119], v[72:75]
    buffer_load_dwordx4 v3, s[4:7], s44 offen offset:0 sc1 lds
    v_mfma_f32_16x16x32_bf16 v[72:75], a[224:227], v[120:123], v[72:75]
    v_permlane16_swap_b32 v48, v49
    v_mfma_f32_16x16x32_bf16 v[72:75], a[236:239], v[124:127], v[72:75]
    s_waitcnt lgkmcnt(0)
    v_permlane16_swap_b32 v50, v51
    v_mfma_f32_16x16x32_bf16 v[76:79], a[0:3], v[88:91], 0
    s_add_u32 m0, s41, 40960
    ds_read_b128 v[108:111], v3 offset:5120
    v_mfma_f32_16x16x32_bf16 v[76:79], a[12:15], v[92:95], v[76:79]
    ds_read_b128 v[112:115], v3 offset:6144
    v_mfma_f32_16x16x32_bf16 v[76:79], a[24:27], v[96:99], v[76:79]
    buffer_store_dwordx4 v[48:51], v33, s[4:7], s45 offen sc1
    v_mfma_f32_16x16x32_bf16 v[76:79], a[36:39], v[100:103], v[76:79]
    ds_read_b128 v[116:119], v3 offset:7168
    v_fmac_f32 v64, v56, v4
    v_mfma_f32_16x16x32_bf16 v[76:79], a[48:51], v[104:107], v[76:79]
    ds_read_b128 v[120:123], v3 offset:8192
    v_fmac_f32 v65, v56, v5
    v_mfma_f32_16x16x32_bf16 v[80:83], a[4:7], v[88:91], 0
    buffer_load_dwordx4 v3, s[4:7], s44 offen offset:1024 sc1 lds
    v_mfma_f32_16x16x32_bf16 v[80:83], a[16:19], v[92:95], v[80:83]
    s_add_u32 m0, s41, 40960
    ds_read_b128 v[124:127], v3 offset:9216
    v_fmac_f32 v68, v56, v8
    v_fmac_f32 v69, v56, v9
    v_mfma_f32_16x16x32_bf16 v[80:83], a[28:31], v[96:99], v[80:83]
    buffer_load_dwordx4 v3, s[4:7], s44 offen offset:2048 sc1 lds
    v_fmac_f32 v72, v56, v12
    v_mfma_f32_16x16x32_bf16 v[80:83], a[40:43], v[100:103], v[80:83]
    v_fmac_f32 v73, v56, v13
    v_mul_f32 v36, v57, v64
    v_mfma_f32_16x16x32_bf16 v[80:83], a[52:55], v[104:107], v[80:83]
    s_add_u32 m0, s41, 40960
    v_mul_f32 v37, v57, v65
    v_mul_f32 v38, v57, v68
    v_mfma_f32_16x16x32_bf16 v[84:87], a[8:11], v[88:91], 0
    v_mul_f32 v39, v57, v69
    v_mul_f32 v40, v57, v72
    v_mfma_f32_16x16x32_bf16 v[84:87], a[20:23], v[92:95], v[84:87]
    buffer_load_dwordx4 v3, s[4:7], s44 offen offset:3072 sc1 lds
    v_mfma_f32_16x16x32_bf16 v[84:87], a[32:35], v[96:99], v[84:87]
    v_mul_f32 v41, v57, v73
    v_mfma_f32_16x16x32_bf16 v[84:87], a[44:47], v[100:103], v[84:87]
    s_add_u32 m0, s41, 45056
    v_exp_f32 v36, v36
    v_mfma_f32_16x16x32_bf16 v[84:87], a[56:59], v[104:107], v[84:87]
    s_waitcnt lgkmcnt(0)
    v_exp_f32 v37, v37
    v_mfma_f32_16x16x32_bf16 v[76:79], a[60:63], v[108:111], v[76:79]
    ds_read_b128 v[88:91], v3 offset:10240
    v_mfma_f32_16x16x32_bf16 v[76:79], a[72:75], v[112:115], v[76:79]
    ds_read_b128 v[92:95], v3 offset:11264
    v_mfma_f32_16x16x32_bf16 v[76:79], a[84:87], v[116:119], v[76:79]
    buffer_load_dwordx4 v24, s[4:7], s44 offen offset:0 sc1 lds
    v_mfma_f32_16x16x32_bf16 v[76:79], a[96:99], v[120:123], v[76:79]
    ds_read_b128 v[96:99], v3 offset:12288
    v_exp_f32 v38, v38
    v_mfma_f32_16x16x32_bf16 v[76:79], a[108:111], v[124:127], v[76:79]
    ds_read_b128 v[100:103], v3 offset:13312
    v_exp_f32 v39, v39
    v_mfma_f32_16x16x32_bf16 v[80:83], a[64:67], v[108:111], v[80:83]
    buffer_load_dwordx4 v[228:231], v34, s[4:7], s52 offen offset:1024 sc1
    v_mfma_f32_16x16x32_bf16 v[80:83], a[76:79], v[112:115], v[80:83]
    s_add_u32 s52, s52, 40960
    ds_read_b128 v[104:107], v3 offset:14336
    v_exp_f32 v40, v40
    v_mfma_f32_16x16x32_bf16 v[80:83], a[88:91], v[116:119], v[80:83]
    v_exp_f32 v41, v41
    v_mfma_f32_16x16x32_bf16 v[80:83], a[100:103], v[120:123], v[80:83]
    v_fmac_f32 v66, v56, v6
    v_fmac_f32 v67, v56, v7
    v_mfma_f32_16x16x32_bf16 v[80:83], a[112:115], v[124:127], v[80:83]
    buffer_load_dwordx4 v[232:235], v34, s[4:7], s52 offen offset:0 sc1
    v_fmac_f32 v70, v56, v10
    v_mfma_f32_16x16x32_bf16 v[84:87], a[68:71], v[108:111], v[84:87]
    v_fmac_f32 v71, v56, v11
    v_fmac_f32 v74, v56, v14
    v_mfma_f32_16x16x32_bf16 v[84:87], a[80:83], v[112:115], v[84:87]
    v_fmac_f32 v75, v56, v15
    v_mul_f32 v42, v64, v66
    v_mfma_f32_16x16x32_bf16 v[84:87], a[92:95], v[116:119], v[84:87]
    v_mul_f32 v43, v65, v67
    v_mul_f32 v44, v68, v70
    v_mfma_f32_16x16x32_bf16 v[84:87], a[104:107], v[120:123], v[84:87]
    buffer_load_dwordx4 v[236:239], v34, s[4:7], s52 offen offset:256 sc1
    v_mfma_f32_16x16x32_bf16 v[84:87], a[116:119], v[124:127], v[84:87]
    s_waitcnt lgkmcnt(0)
    v_mul_f32 v45, v69, v71
    v_mul_f32 v46, v72, v74
    v_mfma_f32_16x16x32_bf16 v[76:79], a[120:123], v[88:91], v[76:79]
    ds_read_b128 v[108:111], v3 offset:15360
    v_mul_f32 v47, v73, v75
    v_mfma_f32_16x16x32_bf16 v[76:79], a[132:135], v[92:95], v[76:79]
    ds_read_b128 v[112:115], v3 offset:16384
    v_add_f32 v36, 1.0, v36
    v_mfma_f32_16x16x32_bf16 v[76:79], a[144:147], v[96:99], v[76:79]
    v_add_f32 v37, 1.0, v37
    v_add_f32 v38, 1.0, v38
    v_mfma_f32_16x16x32_bf16 v[76:79], a[156:159], v[100:103], v[76:79]
    ds_read_b128 v[116:119], v3 offset:17408
    v_add_f32 v39, 1.0, v39
    v_mfma_f32_16x16x32_bf16 v[76:79], a[168:171], v[104:107], v[76:79]
    ds_read_b128 v[120:123], v3 offset:18432
    v_add_f32 v40, 1.0, v40
    v_mfma_f32_16x16x32_bf16 v[80:83], a[124:127], v[88:91], v[80:83]
    buffer_load_dwordx4 v[240:243], v34, s[4:7], s52 offen offset:512 sc1
    v_mfma_f32_16x16x32_bf16 v[80:83], a[136:139], v[92:95], v[80:83]
    ds_read_b128 v[124:127], v3 offset:19456
    v_add_f32 v41, 1.0, v41
    v_mfma_f32_16x16x32_bf16 v[80:83], a[148:151], v[96:99], v[80:83]
    v_rcp_f32 v36, v36
    v_mfma_f32_16x16x32_bf16 v[80:83], a[160:163], v[100:103], v[80:83]
    buffer_load_dwordx4 v[244:247], v34, s[4:7], s52 offen offset:768 sc1
    v_mfma_f32_16x16x32_bf16 v[80:83], a[172:175], v[104:107], v[80:83]
    v_rcp_f32 v37, v37
    v_mfma_f32_16x16x32_bf16 v[84:87], a[128:131], v[88:91], v[84:87]
    v_rcp_f32 v38, v38
    v_mfma_f32_16x16x32_bf16 v[84:87], a[140:143], v[92:95], v[84:87]
    buffer_load_dwordx4 v[248:251], v34, s[4:7], s52 offen offset:1024 sc1
    v_mfma_f32_16x16x32_bf16 v[84:87], a[152:155], v[96:99], v[84:87]
    s_add_u32 s52, s52, 40960
    v_rcp_f32 v39, v39
    v_mfma_f32_16x16x32_bf16 v[84:87], a[164:167], v[100:103], v[84:87]
    v_rcp_f32 v40, v40
    v_mfma_f32_16x16x32_bf16 v[84:87], a[176:179], v[104:107], v[84:87]
    s_waitcnt lgkmcnt(0)
    v_rcp_f32 v41, v41
    v_mfma_f32_16x16x32_bf16 v[76:79], a[180:183], v[108:111], v[76:79]
    s_waitcnt vmcnt(10)
    s_barrier
    v_mfma_f32_16x16x32_bf16 v[76:79], a[192:195], v[112:115], v[76:79]
    ds_read_b128 v[88:91], v3 offset:20480
    v_mul_f32 v42, v42, v36
    v_mfma_f32_16x16x32_bf16 v[76:79], a[204:207], v[116:119], v[76:79]
    buffer_load_dwordx4 v[252:255], v34, s[4:7], s52 offen offset:0 sc1
    v_mul_f32 v43, v43, v37
    v_mfma_f32_16x16x32_bf16 v[76:79], a[216:219], v[120:123], v[76:79]
    s_add_u32 m0, s48, -256
    ds_read_b128 v[92:95], v3 offset:21504
    v_mul_f32 v44, v44, v38
    v_mfma_f32_16x16x32_bf16 v[76:79], a[228:231], v[124:127], v[76:79]
    ds_read_b128 v[96:99], v3 offset:22528
    v_mul_f32 v45, v45, v39
    v_mul_f32 v46, v46, v40
    v_mfma_f32_16x16x32_bf16 v[80:83], a[184:187], v[108:111], v[80:83]
    buffer_load_dwordx4 v34, s[4:7], s57 offen offset:256 sc1 lds
    v_mul_f32 v47, v47, v41
    v_mfma_f32_16x16x32_bf16 v[80:83], a[196:199], v[112:115], v[80:83]
    ds_read_b128 v[100:103], v3 offset:23552
    v_cvt_pk_bf16_f32 v48, v42, v43
    v_mfma_f32_16x16x32_bf16 v[80:83], a[208:211], v[116:119], v[80:83]
    ds_read_b64 v[56:57], v32 offset:1280
    v_cvt_pk_bf16_f32 v50, v46, v47
    v_mfma_f32_16x16x32_bf16 v[80:83], a[220:223], v[120:123], v[80:83]
    s_add_u32 m0, s48, 512
    ds_read_b128 v[104:107], v3 offset:24576
    v_cvt_pk_bf16_f32 v49, v44, v45
    v_mfma_f32_16x16x32_bf16 v[80:83], a[232:235], v[124:127], v[80:83]
    s_add_u32 s45, s43, 49152
    v_add_u32 v29, 1, v29
    v_permlane32_swap_b32 v48, v50
    v_mfma_f32_16x16x32_bf16 v[84:87], a[188:191], v[108:111], v[84:87]
    buffer_load_dwordx4 v34, s[4:7], s57 offen offset:512 sc1 lds
    v_mfma_f32_16x16x32_bf16 v[84:87], a[200:203], v[112:115], v[84:87]
    buffer_store_dword v29, v27, s[4:7], 0 offen sc1
    v_mfma_f32_16x16x32_bf16 v[84:87], a[212:215], v[116:119], v[84:87]
    s_add_u32 s44, s40, 61440
    v_permlane32_swap_b32 v49, v51
    v_mfma_f32_16x16x32_bf16 v[84:87], a[224:227], v[120:123], v[84:87]
    s_add_u32 m0, s41, 0
    v_permlane16_swap_b32 v48, v49
    v_mfma_f32_16x16x32_bf16 v[84:87], a[236:239], v[124:127], v[84:87]
    s_waitcnt lgkmcnt(0)
    v_permlane16_swap_b32 v50, v51
    v_mfma_f32_16x16x32_bf16 v[64:67], a[0:3], v[88:91], 0
    ds_read_b128 v[108:111], v3 offset:25600
    v_mfma_f32_16x16x32_bf16 v[64:67], a[12:15], v[92:95], v[64:67]
    ds_read_b128 v[112:115], v3 offset:26624
    v_mfma_f32_16x16x32_bf16 v[64:67], a[24:27], v[96:99], v[64:67]
    buffer_load_dwordx4 v3, s[4:7], s44 offen offset:0 sc1 lds
    v_mfma_f32_16x16x32_bf16 v[64:67], a[36:39], v[100:103], v[64:67]
    s_add_u32 m0, s41, 0
    ds_read_b128 v[116:119], v3 offset:27648
    v_mfma_f32_16x16x32_bf16 v[64:67], a[48:51], v[104:107], v[64:67]
    ds_read_b128 v[120:123], v3 offset:28672
    v_mfma_f32_16x16x32_bf16 v[68:71], a[4:7], v[88:91], 0
    buffer_store_dwordx4 v[48:51], v33, s[4:7], s45 offen sc1
    v_mfma_f32_16x16x32_bf16 v[68:71], a[16:19], v[92:95], v[68:71]
    ds_read_b128 v[124:127], v3 offset:29696
    v_fmac_f32 v76, v56, v4
    v_fmac_f32 v77, v56, v5
    v_mfma_f32_16x16x32_bf16 v[68:71], a[28:31], v[96:99], v[68:71]
    buffer_load_dwordx4 v3, s[4:7], s44 offen offset:1024 sc1 lds
    v_fmac_f32 v80, v56, v8
    v_mfma_f32_16x16x32_bf16 v[68:71], a[40:43], v[100:103], v[68:71]
    s_add_u32 m0, s41, 0
    v_fmac_f32 v81, v56, v9
    v_fmac_f32 v84, v56, v12
    v_fmac_f32 v85, v56, v13
    v_mfma_f32_16x16x32_bf16 v[68:71], a[52:55], v[104:107], v[68:71]
    buffer_load_dwordx4 v3, s[4:7], s44 offen offset:2048 sc1 lds
    v_mul_f32 v36, v57, v76
    v_mfma_f32_16x16x32_bf16 v[72:75], a[8:11], v[88:91], 0
    s_add_u32 m0, s41, 0
    v_mul_f32 v37, v57, v77
    v_mul_f32 v38, v57, v80
    v_mfma_f32_16x16x32_bf16 v[72:75], a[20:23], v[92:95], v[72:75]
    v_mul_f32 v39, v57, v81
    v_mul_f32 v40, v57, v84
    v_mfma_f32_16x16x32_bf16 v[72:75], a[32:35], v[96:99], v[72:75]
    buffer_load_dwordx4 v3, s[4:7], s44 offen offset:3072 sc1 lds
    v_mfma_f32_16x16x32_bf16 v[72:75], a[44:47], v[100:103], v[72:75]
    v_mul_f32 v41, v57, v85
    v_exp_f32 v36, v36
    v_mfma_f32_16x16x32_bf16 v[72:75], a[56:59], v[104:107], v[72:75]
    s_waitcnt lgkmcnt(0)
    v_exp_f32 v37, v37
    v_mfma_f32_16x16x32_bf16 v[64:67], a[60:63], v[108:111], v[64:67]
    s_add_u32 m0, s41, 4096
    ds_read_b128 v[88:91], v3 offset:30720
    v_mfma_f32_16x16x32_bf16 v[64:67], a[72:75], v[112:115], v[64:67]
    ds_read_b128 v[92:95], v3 offset:31744
    v_mfma_f32_16x16x32_bf16 v[64:67], a[84:87], v[116:119], v[64:67]
    v_exp_f32 v38, v38
    v_mfma_f32_16x16x32_bf16 v[64:67], a[96:99], v[120:123], v[64:67]
    ds_read_b128 v[96:99], v3 offset:32768
    v_exp_f32 v39, v39
    v_mfma_f32_16x16x32_bf16 v[64:67], a[108:111], v[124:127], v[64:67]
    ds_read_b128 v[100:103], v3 offset:33792
    v_mfma_f32_16x16x32_bf16 v[68:71], a[64:67], v[108:111], v[68:71]
    buffer_load_dwordx4 v24, s[4:7], s44 offen offset:0 sc1 lds
    v_mfma_f32_16x16x32_bf16 v[68:71], a[76:79], v[112:115], v[68:71]
    s_add_u32 m0, s48, 1280
    ds_read_b128 v[104:107], v3 offset:34816
    v_exp_f32 v40, v40
    v_mfma_f32_16x16x32_bf16 v[68:71], a[88:91], v[116:119], v[68:71]
    buffer_load_dwordx4 v34, s[4:7], s57 offen offset:768 sc1 lds
    v_mfma_f32_16x16x32_bf16 v[68:71], a[100:103], v[120:123], v[68:71]
    s_add_u32 m0, s48, 2048
    v_exp_f32 v41, v41
    v_fmac_f32 v78, v56, v6
    v_mfma_f32_16x16x32_bf16 v[68:71], a[112:115], v[124:127], v[68:71]
    v_fmac_f32 v79, v56, v7
    v_fmac_f32 v82, v56, v10
    v_mfma_f32_16x16x32_bf16 v[72:75], a[68:71], v[108:111], v[72:75]
    buffer_load_dwordx4 v34, s[4:7], s57 offen offset:1024 sc1 lds
    v_fmac_f32 v83, v56, v11
    v_mfma_f32_16x16x32_bf16 v[72:75], a[80:83], v[112:115], v[72:75]
    s_add_u32 s57, s57, 40960
    v_fmac_f32 v86, v56, v14
    v_fmac_f32 v87, v56, v15
    v_mfma_f32_16x16x32_bf16 v[72:75], a[92:95], v[116:119], v[72:75]
    v_mul_f32 v42, v76, v78
    v_mul_f32 v43, v77, v79
    v_mfma_f32_16x16x32_bf16 v[72:75], a[104:107], v[120:123], v[72:75]
    s_add_u32 m0, s48, 4096
    v_mul_f32 v44, v80, v82
    v_mul_f32 v45, v81, v83
    v_mfma_f32_16x16x32_bf16 v[72:75], a[116:119], v[124:127], v[72:75]
L_hop4:
    s_cbranch_execz L_hopret
    s_waitcnt lgkmcnt(0)
    v_mul_f32 v46, v84, v86
    v_mul_f32 v47, v85, v87
    v_mfma_f32_16x16x32_bf16 v[64:67], a[120:123], v[88:91], v[64:67]
    ds_read_b128 v[108:111], v3 offset:35840
    v_add_f32 v36, 1.0, v36
    v_mfma_f32_16x16x32_bf16 v[64:67], a[132:135], v[92:95], v[64:67]
    ds_read_b128 v[112:115], v3 offset:36864
    v_add_f32 v37, 1.0, v37
    v_mfma_f32_16x16x32_bf16 v[64:67], a[144:147], v[96:99], v[64:67]
    buffer_load_dwordx4 v34, s[4:7], s57 offen offset:0 sc1 lds
    v_mfma_f32_16x16x32_bf16 v[64:67], a[156:159], v[100:103], v[64:67]
    s_add_u32 m0, s48, 4864
    ds_read_b128 v[116:119], v3 offset:37888
    v_add_f32 v38, 1.0, v38
    v_mfma_f32_16x16x32_bf16 v[64:67], a[168:171], v[104:107], v[64:67]
    ds_read_b128 v[120:123], v3 offset:38912
    v_add_f32 v39, 1.0, v39
    v_mfma_f32_16x16x32_bf16 v[68:71], a[124:127], v[88:91], v[68:71]
    buffer_load_dwordx4 v34, s[4:7], s57 offen offset:256 sc1 lds
    v_add_f32 v40, 1.0, v40
    v_mfma_f32_16x16x32_bf16 v[68:71], a[136:139], v[92:95], v[68:71]
    ds_read_b128 v[124:127], v3 offset:39936
    v_add_f32 v41, 1.0, v41
    v_mfma_f32_16x16x32_bf16 v[68:71], a[148:151], v[96:99], v[68:71]
    s_add_u32 m0, s48, 5632
    v_rcp_f32 v36, v36
    v_mfma_f32_16x16x32_bf16 v[68:71], a[160:163], v[100:103], v[68:71]
    v_rcp_f32 v37, v37
    v_mfma_f32_16x16x32_bf16 v[68:71], a[172:175], v[104:107], v[68:71]
    buffer_load_dwordx4 v34, s[4:7], s57 offen offset:512 sc1 lds
    v_mfma_f32_16x16x32_bf16 v[72:75], a[128:131], v[88:91], v[72:75]
    v_rcp_f32 v38, v38
    v_mfma_f32_16x16x32_bf16 v[72:75], a[140:143], v[92:95], v[72:75]
    v_rcp_f32 v39, v39
    v_mfma_f32_16x16x32_bf16 v[72:75], a[152:155], v[96:99], v[72:75]
    v_rcp_f32 v40, v40
    v_mfma_f32_16x16x32_bf16 v[72:75], a[164:167], v[100:103], v[72:75]
    buffer_load_dword v30, v26, s[4:7], 0 offen sc1
    v_mfma_f32_16x16x32_bf16 v[72:75], a[176:179], v[104:107], v[72:75]
    s_waitcnt lgkmcnt(0)
    v_rcp_f32 v41, v41
    v_mfma_f32_16x16x32_bf16 v[64:67], a[180:183], v[108:111], v[64:67]
    s_waitcnt vmcnt(22)
    s_barrier
    v_mfma_f32_16x16x32_bf16 v[64:67], a[192:195], v[112:115], v[64:67]
    s_add_u32 m0, s48, 6400
    ds_read_b128 v[88:91], v3 offset:40960
    v_mul_f32 v42, v42, v36
    v_mfma_f32_16x16x32_bf16 v[64:67], a[204:207], v[116:119], v[64:67]
    buffer_load_dwordx4 v34, s[4:7], s57 offen offset:768 sc1 lds
    v_mul_f32 v43, v43, v37
    v_mfma_f32_16x16x32_bf16 v[64:67], a[216:219], v[120:123], v[64:67]
    ds_read_b128 v[92:95], v3 offset:41984
    v_mul_f32 v44, v44, v38
    v_mfma_f32_16x16x32_bf16 v[64:67], a[228:231], v[124:127], v[64:67]
    ds_read_b128 v[96:99], v3 offset:43008
    v_mul_f32 v45, v45, v39
    v_mul_f32 v46, v46, v40
    v_mfma_f32_16x16x32_bf16 v[68:71], a[184:187], v[108:111], v[68:71]
    s_add_u32 m0, s48, 7168
    v_mul_f32 v47, v47, v41
    v_cvt_pk_bf16_f32 v48, v42, v43
    v_mfma_f32_16x16x32_bf16 v[68:71], a[196:199], v[112:115], v[68:71]
    ds_read_b128 v[100:103], v3 offset:44032
    ds_read_b64 v[56:57], v32 offset:512
    v_mfma_f32_16x16x32_bf16 v[68:71], a[208:211], v[116:119], v[68:71]
    buffer_load_dwordx4 v34, s[4:7], s57 offen offset:1024 sc1 lds
    v_mfma_f32_16x16x32_bf16 v[68:71], a[220:223], v[120:123], v[68:71]
    s_add_u32 s57, s57, 40960
    ds_read_b128 v[104:107], v3 offset:45056
    v_cvt_pk_bf16_f32 v50, v46, v47
    v_cvt_pk_bf16_f32 v49, v44, v45
    v_mfma_f32_16x16x32_bf16 v[68:71], a[232:235], v[124:127], v[68:71]
    s_add_u32 s44, s40, 143360
    s_add_u32 m0, s41, 20480
    s_add_u32 s45, s43, 245760
    v_mfma_f32_16x16x32_bf16 v[72:75], a[188:191], v[108:111], v[72:75]
    v_permlane32_swap_b32 v48, v50
    v_mfma_f32_16x16x32_bf16 v[72:75], a[200:203], v[112:115], v[72:75]
    v_permlane32_swap_b32 v49, v51
    v_mfma_f32_16x16x32_bf16 v[72:75], a[212:215], v[116:119], v[72:75]
    buffer_load_dwordx4 v3, s[4:7], s44 offen offset:0 sc1 lds
    v_mfma_f32_16x16x32_bf16 v[72:75], a[224:227], v[120:123], v[72:75]
    v_permlane16_swap_b32 v48, v49
    v_mfma_f32_16x16x32_bf16 v[72:75], a[236:239], v[124:127], v[72:75]
    s_waitcnt lgkmcnt(0)
    v_permlane16_swap_b32 v50, v51
    v_mfma_f32_16x16x32_bf16 v[76:79], a[0:3], v[88:91], 0
    s_add_u32 m0, s41, 20480
    ds_read_b128 v[108:111], v3 offset:46080
    v_mfma_f32_16x16x32_bf16 v[76:79], a[12:15], v[92:95], v[76:79]
    ds_read_b128 v[112:115], v3 offset:47104
    v_mfma_f32_16x16x32_bf16 v[76:79], a[24:27], v[96:99], v[76:79]
    buffer_store_dwordx4 v[48:51], v33, s[4:7], s45 offen sc1
    v_mfma_f32_16x16x32_bf16 v[76:79], a[36:39], v[100:103], v[76:79]
    ds_read_b128 v[116:119], v3 offset:48128
    v_fmac_f32 v64, v56, v4
    v_mfma_f32_16x16x32_bf16 v[76:79], a[48:51], v[104:107], v[76:79]
    ds_read_b128 v[120:123], v3 offset:49152
    v_fmac_f32 v65, v56, v5
    v_mfma_f32_16x16x32_bf16 v[80:83], a[4:7], v[88:91], 0
    buffer_load_dwordx4 v3, s[4:7], s44 offen offset:1024 sc1 lds
    v_mfma_f32_16x16x32_bf16 v[80:83], a[16:19], v[92:95], v[80:83]
    s_add_u32 m0, s41, 20480
    ds_read_b128 v[124:127], v3 offset:50176
    v_fmac_f32 v68, v56, v8
    v_fmac_f32 v69, v56, v9
    v_mfma_f32_16x16x32_bf16 v[80:83], a[28:31], v[96:99], v[80:83]
    buffer_load_dwordx4 v3, s[4:7], s44 offen offset:2048 sc1 lds
    v_fmac_f32 v72, v56, v12
    v_mfma_f32_16x16x32_bf16 v[80:83], a[40:43], v[100:103], v[80:83]
    s_add_u32 m0, s41, 20480
    v_fmac_f32 v73, v56, v13
    v_mul_f32 v36, v57, v64
    v_mfma_f32_16x16x32_bf16 v[80:83], a[52:55], v[104:107], v[80:83]
    buffer_load_dwordx4 v3, s[4:7], s44 offen offset:3072 sc1 lds
    v_mul_f32 v37, v57, v65
    v_mfma_f32_16x16x32_bf16 v[84:87], a[8:11], v[88:91], 0
    v_mul_f32 v38, v57, v68
    v_mul_f32 v39, v57, v69
    v_mfma_f32_16x16x32_bf16 v[84:87], a[20:23], v[92:95], v[84:87]
    v_mul_f32 v40, v57, v72
    v_mul_f32 v41, v57, v73
    v_mfma_f32_16x16x32_bf16 v[84:87], a[32:35], v[96:99], v[84:87]
    s_add_u32 m0, s41, 24576
    v_exp_f32 v36, v36
    v_mfma_f32_16x16x32_bf16 v[84:87], a[44:47], v[100:103], v[84:87]
    v_exp_f32 v37, v37
    v_mfma_f32_16x16x32_bf16 v[84:87], a[56:59], v[104:107], v[84:87]
    s_waitcnt lgkmcnt(0)
    v_exp_f32 v38, v38
    v_mfma_f32_16x16x32_bf16 v[76:79], a[60:63], v[108:111], v[76:79]
    ds_read_b128 v[88:91], v3 offset:51200
    v_mfma_f32_16x16x32_bf16 v[76:79], a[72:75], v[112:115], v[76:79]
    ds_read_b128 v[92:95], v3 offset:52224
    v_mfma_f32_16x16x32_bf16 v[76:79], a[84:87], v[116:119], v[76:79]
    buffer_load_dwordx4 v24, s[4:7], s44 offen offset:0 sc1 lds
    v_mfma_f32_16x16x32_bf16 v[76:79], a[96:99], v[120:123], v[76:79]
    s_add_u32 m0, s48, 9216
    ds_read_b128 v[96:99], v3 offset:53248
    v_exp_f32 v39, v39
    v_mfma_f32_16x16x32_bf16 v[76:79], a[108:111], v[124:127], v[76:79]
    ds_read_b128 v[100:103], v3 offset:54272
    v_mfma_f32_16x16x32_bf16 v[80:83], a[64:67], v[108:111], v[80:83]
    buffer_load_dwordx4 v34, s[4:7], s57 offen offset:0 sc1 lds
    v_mfma_f32_16x16x32_bf16 v[80:83], a[76:79], v[112:115], v[80:83]
    s_add_u32 m0, s48, 9984
    ds_read_b128 v[104:107], v3 offset:55296
    v_exp_f32 v40, v40
    v_mfma_f32_16x16x32_bf16 v[80:83], a[88:91], v[116:119], v[80:83]
    v_exp_f32 v41, v41
    v_mfma_f32_16x16x32_bf16 v[80:83], a[100:103], v[120:123], v[80:83]
    buffer_load_dwordx4 v34, s[4:7], s57 offen offset:256 sc1 lds
    v_fmac_f32 v66, v56, v6
    v_mfma_f32_16x16x32_bf16 v[80:83], a[112:115], v[124:127], v[80:83]
    v_fmac_f32 v67, v56, v7
    v_fmac_f32 v70, v56, v10
    v_mfma_f32_16x16x32_bf16 v[84:87], a[68:71], v[108:111], v[84:87]
    s_add_u32 m0, s48, 10752
    v_fmac_f32 v71, v56, v11
    v_fmac_f32 v74, v56, v14
    v_mfma_f32_16x16x32_bf16 v[84:87], a[80:83], v[112:115], v[84:87]
    v_fmac_f32 v75, v56, v15
    v_mul_f32 v42, v64, v66
    v_mfma_f32_16x16x32_bf16 v[84:87], a[92:95], v[116:119], v[84:87]
    buffer_load_dwordx4 v34, s[4:7], s57 offen offset:512 sc1 lds
    v_mfma_f32_16x16x32_bf16 v[84:87], a[104:107], v[120:123], v[84:87]
    v_mul_f32 v43, v65, v67
    v_mul_f32 v44, v68, v70
    v_mfma_f32_16x16x32_bf16 v[84:87], a[116:119], v[124:127], v[84:87]
    s_waitcnt lgkmcnt(0)
    s_add_u32 m0, s48, 11520
    v_mul_f32 v45, v69, v71
    v_mfma_f32_16x16x32_bf16 v[76:79], a[120:123], v[88:91], v[76:79]
    ds_read_b128 v[108:111], v3 offset:56320
    v_mul_f32 v46, v72, v74
    v_mfma_f32_16x16x32_bf16 v[76:79], a[132:135], v[92:95], v[76:79]
    ds_read_b128 v[112:115], v3 offset:57344
    v_mul_f32 v47, v73, v75
    v_mfma_f32_16x16x32_bf16 v[76:79], a[144:147], v[96:99], v[76:79]
    buffer_load_dwordx4 v34, s[4:7], s57 offen offset:768 sc1 lds
    v_add_f32 v36, 1.0, v36
    v_mfma_f32_16x16x32_bf16 v[76:79], a[156:159], v[100:103], v[76:79]
    ds_read_b128 v[116:119], v3 offset:58368
    v_add_f32 v37, 1.0, v37
    v_mfma_f32_16x16x32_bf16 v[76:79], a[168:171], v[104:107], v[76:79]
    s_add_u32 m0, s48, 12288
    ds_read_b128 v[120:123], v3 offset:59392
    v_add_f32 v38, 1.0, v38
    v_mfma_f32_16x16x32_bf16 v[80:83], a[124:127], v[88:91], v[80:83]
    v_add_f32 v39, 1.0, v39
    v_add_f32 v40, 1.0, v40
    v_mfma_f32_16x16x32_bf16 v[80:83], a[136:139], v[92:95], v[80:83]
    ds_read_b128 v[124:127], v3 offset:60416
    v_add_f32 v41, 1.0, v41
    v_mfma_f32_16x16x32_bf16 v[80:83], a[148:151], v[96:99], v[80:83]
    buffer_load_dwordx4 v34, s[4:7], s57 offen offset:1024 sc1 lds
    v_mfma_f32_16x16x32_bf16 v[80:83], a[160:163], v[100:103], v[80:83]
    s_add_u32 s57, s57, 40960
    v_rcp_f32 v36, v36
    v_mfma_f32_16x16x32_bf16 v[80:83], a[172:175], v[104:107], v[80:83]
    s_waitcnt vmcnt(13)
    v_rcp_f32 v37, v37
    v_mfma_f32_16x16x32_bf16 v[84:87], a[128:131], v[88:91], v[84:87]
    v_subrev_u32 v30, s32, v30
    v_cmp_lt_u32 vcc, 3, v30
    v_mfma_f32_16x16x32_bf16 v[84:87], a[140:143], v[92:95], v[84:87]
    s_cbranch_vccnz L_slow4
L_back4:
    s_add_u32 s49, s46, 0
    v_rcp_f32 v38, v38
    v_mfma_f32_16x16x32_bf16 v[84:87], a[152:155], v[96:99], v[84:87]
    buffer_load_dwordx4 a[240:243], v3, s[4:7], s49 offen offset:0 sc1
    v_mfma_f32_16x16x32_bf16 v[84:87], a[164:167], v[100:103], v[84:87]
    v_rcp_f32 v39, v39
    v_mfma_f32_16x16x32_bf16 v[84:87], a[176:179], v[104:107], v[84:87]
    s_waitcnt lgkmcnt(0)
    v_rcp_f32 v40, v40
    v_mfma_f32_16x16x32_bf16 v[76:79], a[180:183], v[108:111], v[76:79]
    s_waitcnt vmcnt(10)
    s_barrier
    v_mfma_f32_16x16x32_bf16 v[76:79], a[192:195], v[112:115], v[76:79]
    ds_read_b128 v[88:91], v3 offset:0
    v_rcp_f32 v41, v41
    v_mfma_f32_16x16x32_bf16 v[76:79], a[204:207], v[116:119], v[76:79]
    buffer_load_dwordx4 a[244:247], v3, s[4:7], s49 offen offset:1024 sc1
    v_mul_f32 v42, v42, v36
    v_mfma_f32_16x16x32_bf16 v[76:79], a[216:219], v[120:123], v[76:79]
    ds_read_b128 v[92:95], v3 offset:1024
    v_mul_f32 v43, v43, v37
    v_mul_f32 v44, v44, v38
    v_mfma_f32_16x16x32_bf16 v[76:79], a[228:231], v[124:127], v[76:79]
    ds_read_b128 v[96:99], v3 offset:2048
    v_mul_f32 v45, v45, v39
    v_mul_f32 v46, v46, v40
    v_mfma_f32_16x16x32_bf16 v[80:83], a[184:187], v[108:111], v[80:83]
    buffer_load_dwordx4 a[248:251], v3, s[4:7], s49 offen offset:2048 sc1
    v_mul_f32 v47, v47, v41
    v_mfma_f32_16x16x32_bf16 v[80:83], a[196:199], v[112:115], v[80:83]
    s_add_u32 s49, s46, 3072
    ds_read_b128 v[100:103], v3 offset:3072
    v_cvt_pk_bf16_f32 v48, v42, v43
    v_mfma_f32_16x16x32_bf16 v[80:83], a[208:211], v[116:119], v[80:83]
    ds_read_b64 v[56:57], v32 offset:1536
    v_cvt_pk_bf16_f32 v50, v46, v47
    v_mfma_f32_16x16x32_bf16 v[80:83], a[220:223], v[120:123], v[80:83]
    ds_read_b128 v[104:107], v3 offset:4096
    v_cvt_pk_bf16_f32 v49, v44, v45
    v_mfma_f32_16x16x32_bf16 v[80:83], a[232:235], v[124:127], v[80:83]
    s_add_u32 s45, s43, 98304
    v_add_u32 v29, 1, v29
    v_permlane32_swap_b32 v48, v50
    v_mfma_f32_16x16x32_bf16 v[84:87], a[188:191], v[108:111], v[84:87]
    buffer_load_dwordx4 a[252:255], v3, s[4:7], s49 offen offset:0 sc1
    v_mfma_f32_16x16x32_bf16 v[84:87], a[200:203], v[112:115], v[84:87]
    buffer_store_dword v29, v27, s[4:7], 0 offen sc1
    v_mfma_f32_16x16x32_bf16 v[84:87], a[212:215], v[116:119], v[84:87]
    v_permlane32_swap_b32 v49, v51
    v_mfma_f32_16x16x32_bf16 v[84:87], a[224:227], v[120:123], v[84:87]
    s_nop 0
    v_permlane16_swap_b32 v48, v49
    v_mfma_f32_16x16x32_bf16 v[84:87], a[236:239], v[124:127], v[84:87]
    s_waitcnt lgkmcnt(0)
    v_permlane16_swap_b32 v50, v51
    v_mfma_f32_16x16x32_bf16 v[64:67], a[0:3], v[88:91], 0
    ds_read_b128 v[108:111], v3 offset:5120
    v_mfma_f32_16x16x32_bf16 v[64:67], a[12:15], v[92:95], v[64:67]
    ds_read_b128 v[112:115], v3 offset:6144
    v_mfma_f32_16x16x32_bf16 v[64:67], a[24:27], v[96:99], v[64:67]
    buffer_load_dwordx4 v[128:131], v3, s[4:7], s49 offen offset:1024 sc1
    v_mfma_f32_16x16x32_bf16 v[64:67], a[36:39], v[100:103], v[64:67]
    ds_read_b128 v[116:119], v3 offset:7168
    v_mfma_f32_16x16x32_bf16 v[64:67], a[48:51], v[104:107], v[64:67]
    ds_read_b128 v[120:123], v3 offset:8192
    v_mfma_f32_16x16x32_bf16 v[68:71], a[4:7], v[88:91], 0
    buffer_store_dwordx4 v[48:51], v33, s[4:7], s45 offen sc1
    v_mfma_f32_16x16x32_bf16 v[68:71], a[16:19], v[92:95], v[68:71]
    ds_read_b128 v[124:127], v3 offset:9216
    v_fmac_f32 v76, v56, v4
    v_fmac_f32 v77, v56, v5
    v_mfma_f32_16x16x32_bf16 v[68:71], a[28:31], v[96:99], v[68:71]
    buffer_load_dwordx4 v[52:55], v3, s[4:7], s49 offen offset:2048 sc1
    v_fmac_f32 v80, v56, v8
    v_mfma_f32_16x16x32_bf16 v[68:71], a[40:43], v[100:103], v[68:71]
    s_add_u32 m0, s48, 14336
    v_fmac_f32 v81, v56, v9
    v_fmac_f32 v84, v56, v12
    v_fmac_f32 v85, v56, v13
    v_mfma_f32_16x16x32_bf16 v[68:71], a[52:55], v[104:107], v[68:71]
    buffer_load_dwordx4 v34, s[4:7], s57 offen offset:0 sc1 lds
    v_mul_f32 v36, v57, v76
    v_mfma_f32_16x16x32_bf16 v[72:75], a[8:11], v[88:91], 0
    s_add_u32 m0, s48, 15104
    v_mul_f32 v37, v57, v77
    v_mul_f32 v38, v57, v80
    v_mfma_f32_16x16x32_bf16 v[72:75], a[20:23], v[92:95], v[72:75]
    buffer_load_dwordx4 v34, s[4:7], s57 offen offset:256 sc1 lds
    v_mul_f32 v39, v57, v81
    v_mfma_f32_16x16x32_bf16 v[72:75], a[32:35], v[96:99], v[72:75]
    v_mul_f32 v40, v57, v84
    v_mul_f32 v41, v57, v85
    v_mfma_f32_16x16x32_bf16 v[72:75], a[44:47], v[100:103], v[72:75]
    s_add_u32 m0, s48, 15872
    v_exp_f32 v36, v36
    v_mfma_f32_16x16x32_bf16 v[72:75], a[56:59], v[104:107], v[72:75]
    s_waitcnt lgkmcnt(0)
    v_exp_f32 v37, v37
    v_mfma_f32_16x16x32_bf16 v[64:67], a[60:63], v[108:111], v[64:67]
    ds_read_b128 v[88:91], v3 offset:10240
    v_mfma_f32_16x16x32_bf16 v[64:67], a[72:75], v[112:115], v[64:67]
    ds_read_b128 v[92:95], v3 offset:11264
    v_mfma_f32_16x16x32_bf16 v[64:67], a[84:87], v[116:119], v[64:67]
    buffer_load_dwordx4 v34, s[4:7], s57 offen offset:512 sc1 lds
    v_mfma_f32_16x16x32_bf16 v[64:67], a[96:99], v[120:123], v[64:67]
    s_add_u32 m0, s48, 16640
    ds_read_b128 v[96:99], v3 offset:12288
    v_exp_f32 v38, v38
    v_mfma_f32_16x16x32_bf16 v[64:67], a[108:111], v[124:127], v[64:67]
    ds_read_b128 v[100:103], v3 offset:13312
    v_exp_f32 v39, v39
    v_mfma_f32_16x16x32_bf16 v[68:71], a[64:67], v[108:111], v[68:71]
    v_exp_f32 v40, v40
    v_mfma_f32_16x16x32_bf16 v[68:71], a[76:79], v[112:115], v[68:71]
    ds_read_b128 v[104:107], v3 offset:14336
    v_exp_f32 v41, v41
    v_mfma_f32_16x16x32_bf16 v[68:71], a[88:91], v[116:119], v[68:71]
    buffer_load_dwordx4 v34, s[4:7], s57 offen offset:768 sc1 lds
    v_mfma_f32_16x16x32_bf16 v[68:71], a[100:103], v[120:123], v[68:71]
    s_add_u32 m0, s48, 17408
    v_fmac_f32 v78, v56, v6
    v_fmac_f32 v79, v56, v7
    v_mfma_f32_16x16x32_bf16 v[68:71], a[112:115], v[124:127], v[68:71]
    buffer_load_dwordx4 v34, s[4:7], s57 offen offset:1024 sc1 lds
    v_fmac_f32 v82, v56, v10
    v_mfma_f32_16x16x32_bf16 v[72:75], a[68:71], v[108:111], v[72:75]
    s_add_u32 s57, s57, 40960
    v_fmac_f32 v83, v56, v11
    v_fmac_f32 v86, v56, v14
    v_mfma_f32_16x16x32_bf16 v[72:75], a[80:83], v[112:115], v[72:75]
    s_add_u32 m0, s41, 40960
    v_fmac_f32 v87, v56, v15
    v_mul_f32 v42, v76, v78
    v_mfma_f32_16x16x32_bf16 v[72:75], a[92:95], v[116:119], v[72:75]
    v_mul_f32 v43, v77, v79
    v_mul_f32 v44, v80, v82
    v_mfma_f32_16x16x32_bf16 v[72:75], a[104:107], v[120:123], v[72:75]
    buffer_load_dwordx4 v34, s[4:7], s57 offen offset:0 sc1 lds
    v_mfma_f32_16x16x32_bf16 v[72:75], a[116:119], v[124:127], v[72:75]
    s_waitcnt lgkmcnt(0)
    v_mul_f32 v45, v81, v83
    v_mul_f32 v46, v84, v86
    v_mfma_f32_16x16x32_bf16 v[64:67], a[120:123], v[88:91], v[64:67]
    ds_read_b128 v[108:111], v3 offset:15360
    v_mul_f32 v47, v85, v87
    v_mfma_f32_16x16x32_bf16 v[64:67], a[132:135], v[92:95], v[64:67]
    s_add_u32 m0, s41, 41728
    ds_read_b128 v[112:115], v3 offset:16384
    v_add_f32 v36, 1.0, v36
    v_mfma_f32_16x16x32_bf16 v[64:67], a[144:147], v[96:99], v[64:67]
    v_add_f32 v37, 1.0, v37
    v_add_f32 v38, 1.0, v38
    v_mfma_f32_16x16x32_bf16 v[64:67], a[156:159], v[100:103], v[64:67]
    ds_read_b128 v[116:119], v3 offset:17408
    v_add_f32 v39, 1.0, v39
    v_mfma_f32_16x16x32_bf16 v[64:67], a[168:171], v[104:107], v[64:67]
    ds_read_b128 v[120:123], v3 offset:18432
    v_add_f32 v40, 1.0, v40
    v_mfma_f32_16x16x32_bf16 v[68:71], a[124:127], v[88:91], v[68:71]
    buffer_load_dwordx4 v34, s[4:7], s57 offen offset:256 sc1 lds
    v_mfma_f32_16x16x32_bf16 v[68:71], a[136:139], v[92:95], v[68:71]
    s_add_u32 m0, s41, 42496
    ds_read_b128 v[124:127], v3 offset:19456
    v_add_f32 v41, 1.0, v41
    v_mfma_f32_16x16x32_bf16 v[68:71], a[148:151], v[96:99], v[68:71]
    v_rcp_f32 v36, v36
    v_mfma_f32_16x16x32_bf16 v[68:71], a[160:163], v[100:103], v[68:71]
    buffer_load_dwordx4 v34, s[4:7], s57 offen offset:512 sc1 lds
    v_mfma_f32_16x16x32_bf16 v[68:71], a[172:175], v[104:107], v[68:71]
    v_rcp_f32 v37, v37
    v_mfma_f32_16x16x32_bf16 v[72:75], a[128:131], v[88:91], v[72:75]
    v_rcp_f32 v38, v38
    v_mfma_f32_16x16x32_bf16 v[72:75], a[140:143], v[92:95], v[72:75]
    v_rcp_f32 v39, v39
    v_mfma_f32_16x16x32_bf16 v[72:75], a[152:155], v[96:99], v[72:75]
    buffer_load_dword v30, v26, s[4:7], 0 offen sc1
    v_mfma_f32_16x16x32_bf16 v[72:75], a[164:167], v[100:103], v[72:75]
    v_rcp_f32 v40, v40
    v_mfma_f32_16x16x32_bf16 v[72:75], a[176:179], v[104:107], v[72:75]
    s_waitcnt lgkmcnt(0)
    s_add_u32 m0, s41, 43264
    v_mfma_f32_16x16x32_bf16 v[64:67], a[180:183], v[108:111], v[64:67]
    s_waitcnt vmcnt(22)
    s_barrier
    v_mfma_f32_16x16x32_bf16 v[64:67], a[192:195], v[112:115], v[64:67]
    ds_read_b128 v[88:91], v3 offset:20480
    v_rcp_f32 v41, v41
    v_mfma_f32_16x16x32_bf16 v[64:67], a[204:207], v[116:119], v[64:67]
    buffer_load_dwordx4 v34, s[4:7], s57 offen offset:768 sc1 lds
    v_mul_f32 v42, v42, v36
    v_mfma_f32_16x16x32_bf16 v[64:67], a[216:219], v[120:123], v[64:67]
    s_add_u32 m0, s41, 44032
    ds_read_b128 v[92:95], v3 offset:21504
    v_mul_f32 v43, v43, v37
    v_mul_f32 v44, v44, v38
    v_mfma_f32_16x16x32_bf16 v[64:67], a[228:231], v[124:127], v[64:67]
    ds_read_b128 v[96:99], v3 offset:22528
    v_mul_f32 v45, v45, v39
    v_mul_f32 v46, v46, v40
    v_mfma_f32_16x16x32_bf16 v[68:71], a[184:187], v[108:111], v[68:71]
    buffer_load_dwordx4 v34, s[4:7], s57 offen offset:1024 sc1 lds
    v_mul_f32 v47, v47, v41
    v_mfma_f32_16x16x32_bf16 v[68:71], a[196:199], v[112:115], v[68:71]
    s_add_u32 s57, s57, 40960
    ds_read_b128 v[100:103], v3 offset:23552
    v_cvt_pk_bf16_f32 v48, v42, v43
    v_mfma_f32_16x16x32_bf16 v[68:71], a[208:211], v[116:119], v[68:71]
    ds_read_b64 v[56:57], v32 offset:768
    v_cvt_pk_bf16_f32 v50, v46, v47
    v_mfma_f32_16x16x32_bf16 v[68:71], a[220:223], v[120:123], v[68:71]
    ds_read_b128 v[104:107], v3 offset:24576
    v_cvt_pk_bf16_f32 v49, v44, v45
    v_mfma_f32_16x16x32_bf16 v[68:71], a[232:235], v[124:127], v[68:71]
    s_add_u32 m0, s41, 0
    s_add_u32 s45, s43, 294912
    v_permlane32_swap_b32 v48, v50
    v_mfma_f32_16x16x32_bf16 v[72:75], a[188:191], v[108:111], v[72:75]
    v_permlane32_swap_b32 v49, v51
    v_mfma_f32_16x16x32_bf16 v[72:75], a[200:203], v[112:115], v[72:75]
    buffer_load_dwordx4 v34, s[4:7], s57 offen offset:0 sc1 lds
    v_mfma_f32_16x16x32_bf16 v[72:75], a[212:215], v[116:119], v[72:75]
    v_permlane16_swap_b32 v48, v49
    v_mfma_f32_16x16x32_bf16 v[72:75], a[224:227], v[120:123], v[72:75]
    s_add_u32 m0, s41, 768
    v_permlane16_swap_b32 v50, v51
    v_mfma_f32_16x16x32_bf16 v[72:75], a[236:239], v[124:127], v[72:75]
    s_waitcnt lgkmcnt(0)
    v_mfma_f32_16x16x32_bf16 v[76:79], a[0:3], v[88:91], 0
    ds_read_b128 v[108:111], v3 offset:25600
    v_mfma_f32_16x16x32_bf16 v[76:79], a[12:15], v[92:95], v[76:79]
    ds_read_b128 v[112:115], v3 offset:26624
    v_mfma_f32_16x16x32_bf16 v[76:79], a[24:27], v[96:99], v[76:79]
    buffer_load_dwordx4 v34, s[4:7], s57 offen offset:256 sc1 lds
    v_mfma_f32_16x16x32_bf16 v[76:79], a[36:39], v[100:103], v[76:79]
    s_add_u32 m0, s41, 1536
    ds_read_b128 v[116:119], v3 offset:27648
    v_mfma_f32_16x16x32_bf16 v[76:79], a[48:51], v[104:107], v[76:79]
    ds_read_b128 v[120:123], v3 offset:28672
    v_mfma_f32_16x16x32_bf16 v[80:83], a[4:7], v[88:91], 0
    buffer_store_dwordx4 v[48:51], v33, s[4:7], s45 offen sc1
    v_mfma_f32_16x16x32_bf16 v[80:83], a[16:19], v[92:95], v[80:83]
    ds_read_b128 v[124:127], v3 offset:29696
    v_fmac_f32 v64, v56, v4
    v_fmac_f32 v65, v56, v5
    v_mfma_f32_16x16x32_bf16 v[80:83], a[28:31], v[96:99], v[80:83]
    buffer_load_dwordx4 v34, s[4:7], s57 offen offset:512 sc1 lds
    v_fmac_f32 v68, v56, v8
    v_mfma_f32_16x16x32_bf16 v[80:83], a[40:43], v[100:103], v[80:83]
    s_add_u32 m0, s41, 2304
    v_fmac_f32 v69, v56, v9
    v_fmac_f32 v72, v56, v12
    v_fmac_f32 v73, v56, v13
    v_mfma_f32_16x16x32_bf16 v[80:83], a[52:55], v[104:107], v[80:83]
    buffer_load_dwordx4 v34, s[4:7], s57 offen offset:768 sc1 lds
    v_mul_f32 v36, v57, v64
    v_mfma_f32_16x16x32_bf16 v[84:87], a[8:11], v[88:91], 0
    v_mul_f32 v37, v57, v65
    v_mul_f32 v38, v57, v68
    v_mul_f32 v39, v57, v69
    v_mfma_f32_16x16x32_bf16 v[84:87], a[20:23], v[92:95], v[84:87]
    s_add_u32 m0, s41, 3072
    v_mul_f32 v40, v57, v72
    v_mul_f32 v41, v57, v73
    v_mfma_f32_16x16x32_bf16 v[84:87], a[32:35], v[96:99], v[84:87]
    v_exp_f32 v36, v36
    v_mfma_f32_16x16x32_bf16 v[84:87], a[44:47], v[100:103], v[84:87]
    buffer_load_dwordx4 v34, s[4:7], s57 offen offset:1024 sc1 lds
    v_mfma_f32_16x16x32_bf16 v[84:87], a[56:59], v[104:107], v[84:87]
    s_waitcnt lgkmcnt(0)
    s_add_u32 s57, s57, 40960
    v_exp_f32 v37, v37
    v_mfma_f32_16x16x32_bf16 v[76:79], a[60:63], v[108:111], v[76:79]
    ds_read_b128 v[88:91], v3 offset:30720
    v_exp_f32 v38, v38
    v_mfma_f32_16x16x32_bf16 v[76:79], a[72:75], v[112:115], v[76:79]
    ds_read_b128 v[92:95], v3 offset:31744
    v_exp_f32 v39, v39
    v_mfma_f32_16x16x32_bf16 v[76:79], a[84:87], v[116:119], v[76:79]
    v_exp_f32 v40, v40
    v_mfma_f32_16x16x32_bf16 v[76:79], a[96:99], v[120:123], v[76:79]
    s_waitcnt vmcnt(8)
    ds_read_b128 v[96:99], v3 offset:32768
    v_mfma_f32_16x16x32_bf16 v[76:79], a[108:111], v[124:127], v[76:79]
    ds_read_b128 v[100:103], v3 offset:33792
    v_exp_f32 v41, v41
    v_mfma_f32_16x16x32_bf16 v[80:83], a[64:67], v[108:111], v[80:83]
    v_subrev_u32 v30, s33, v30
    v_cmp_lt_u32 vcc, 2, v30
    v_fmac_f32 v66, v56, v6
    v_mfma_f32_16x16x32_bf16 v[80:83], a[76:79], v[112:115], v[80:83]
    s_cbranch_vccnz L_slow5
L_back5:
    s_add_u32 s49, s46, 49152
    ds_read_b128 v[104:107], v3 offset:34816
    v_fmac_f32 v67, v56, v7
    v_mfma_f32_16x16x32_bf16 v[80:83], a[88:91], v[116:119], v[80:83]
    buffer_load_dwordx4 a[0:3], v3, s[4:7], s49 offen offset:0 sc1
    v_fmac_f32 v70, v56, v10
    v_mfma_f32_16x16x32_bf16 v[80:83], a[100:103], v[120:123], v[80:83]
    v_fmac_f32 v71, v56, v11
    v_fmac_f32 v74, v56, v14
    v_mfma_f32_16x16x32_bf16 v[80:83], a[112:115], v[124:127], v[80:83]
    v_fmac_f32 v75, v56, v15
    v_mul_f32 v42, v64, v66
    v_mfma_f32_16x16x32_bf16 v[84:87], a[68:71], v[108:111], v[84:87]
    buffer_load_dwordx4 a[4:7], v3, s[4:7], s49 offen offset:1024 sc1
    v_mul_f32 v43, v65, v67
    v_mfma_f32_16x16x32_bf16 v[84:87], a[80:83], v[112:115], v[84:87]
    v_mul_f32 v44, v68, v70
    v_mul_f32 v45, v69, v71
    v_mfma_f32_16x16x32_bf16 v[84:87], a[92:95], v[116:119], v[84:87]
    v_mul_f32 v46, v72, v74
    v_mul_f32 v47, v73, v75
    v_mfma_f32_16x16x32_bf16 v[84:87], a[104:107], v[120:123], v[84:87]
    buffer_load_dwordx4 a[8:11], v3, s[4:7], s49 offen offset:2048 sc1
    v_add_f32 v36, 1.0, v36
    v_mfma_f32_16x16x32_bf16 v[84:87], a[116:119], v[124:127], v[84:87]
    s_waitcnt lgkmcnt(0)
    v_add_f32 v37, 1.0, v37
    v_add_f32 v38, 1.0, v38
    v_mfma_f32_16x16x32_bf16 v[76:79], a[120:123], v[88:91], v[76:79]
    s_add_u32 s49, s46, 52224
    ds_read_b128 v[108:111], v3 offset:35840
    v_add_f32 v39, 1.0, v39
    v_mfma_f32_16x16x32_bf16 v[76:79], a[132:135], v[92:95], v[76:79]
    ds_read_b128 v[112:115], v3 offset:36864
    v_add_f32 v40, 1.0, v40
    v_mfma_f32_16x16x32_bf16 v[76:79], a[144:147], v[96:99], v[76:79]
    v_add_f32 v41, 1.0, v41
    v_rcp_f32 v36, v36
    v_mfma_f32_16x16x32_bf16 v[76:79], a[156:159], v[100:103], v[76:79]
    ds_read_b128 v[116:119], v3 offset:37888
    v_mfma_f32_16x16x32_bf16 v[76:79], a[168:171], v[104:107], v[76:79]
    ds_read_b128 v[120:123], v3 offset:38912
    v_rcp_f32 v37, v37
    v_mfma_f32_16x16x32_bf16 v[80:83], a[124:127], v[88:91], v[80:83]
    buffer_load_dwordx4 a[12:15], v3, s[4:7], s49 offen offset:0 sc1
    v_mfma_f32_16x16x32_bf16 v[80:83], a[136:139], v[92:95], v[80:83]
    ds_read_b128 v[124:127], v3 offset:39936
    v_rcp_f32 v38, v38
    v_mfma_f32_16x16x32_bf16 v[80:83], a[148:151], v[96:99], v[80:83]
    v_rcp_f32 v39, v39
    v_mfma_f32_16x16x32_bf16 v[80:83], a[160:163], v[100:103], v[80:83]
    buffer_load_dwordx4 a[16:19], v3, s[4:7], s49 offen offset:1024 sc1
    v_mfma_f32_16x16x32_bf16 v[80:83], a[172:175], v[104:107], v[80:83]
    v_rcp_f32 v40, v40
    v_mfma_f32_16x16x32_bf16 v[84:87], a[128:131], v[88:91], v[84:87]
    v_rcp_f32 v41, v41
    v_mul_f32 v42, v42, v36
    v_mfma_f32_16x16x32_bf16 v[84:87], a[140:143], v[92:95], v[84:87]
    buffer_load_dwordx4 a[20:23], v3, s[4:7], s49 offen offset:2048 sc1
    v_mul_f32 v43, v43, v37
    v_mfma_f32_16x16x32_bf16 v[84:87], a[152:155], v[96:99], v[84:87]
    v_mul_f32 v44, v44, v38
    v_mul_f32 v45, v45, v39
    v_mfma_f32_16x16x32_bf16 v[84:87], a[164:167], v[100:103], v[84:87]
    s_add_u32 s49, s46, 6144
    v_mul_f32 v46, v46, v40
    v_mul_f32 v47, v47, v41
    v_mfma_f32_16x16x32_bf16 v[84:87], a[176:179], v[104:107], v[84:87]
    s_waitcnt lgkmcnt(0)
    v_cvt_pk_bf16_f32 v48, v42, v43
    v_mfma_f32_16x16x32_bf16 v[76:79], a[180:183], v[108:111], v[76:79]
    buffer_load_dwordx4 a[24:27], v3, s[4:7], s49 offen offset:0 sc1
    ds_read_b64 v[56:57], v32 offset:1792
    v_mfma_f32_16x16x32_bf16 v[76:79], a[192:195], v[112:115], v[76:79]
    v_cvt_pk_bf16_f32 v50, v46, v47
    v_cvt_pk_bf16_f32 v49, v44, v45
    v_mfma_f32_16x16x32_bf16 v[76:79], a[204:207], v[116:119], v[76:79]
    s_add_u32 s45, s43, 147456
    v_permlane32_swap_b32 v48, v50
    v_mfma_f32_16x16x32_bf16 v[76:79], a[216:219], v[120:123], v[76:79]
    v_permlane32_swap_b32 v49, v51
    v_mfma_f32_16x16x32_bf16 v[76:79], a[228:231], v[124:127], v[76:79]
    s_nop 0
    v_permlane16_swap_b32 v48, v49
    v_mfma_f32_16x16x32_bf16 v[80:83], a[184:187], v[108:111], v[80:83]
    buffer_load_dwordx4 a[28:31], v3, s[4:7], s49 offen offset:1024 sc1
    v_mfma_f32_16x16x32_bf16 v[80:83], a[196:199], v[112:115], v[80:83]
    v_permlane16_swap_b32 v50, v51
    v_mfma_f32_16x16x32_bf16 v[80:83], a[208:211], v[116:119], v[80:83]
    buffer_store_dwordx4 v[48:51], v33, s[4:7], s45 offen sc1
    v_mfma_f32_16x16x32_bf16 v[80:83], a[220:223], v[120:123], v[80:83]
    s_waitcnt vmcnt(12)
    s_barrier
    v_mfma_f32_16x16x32_bf16 v[80:83], a[232:235], v[124:127], v[80:83]
    buffer_load_dwordx4 a[32:35], v3, s[4:7], s49 offen offset:2048 sc1
    v_mfma_f32_16x16x32_bf16 v[84:87], a[188:191], v[108:111], v[84:87]
    v_add_u32 v29, 1, v29
    buffer_store_dword v29, v27, s[4:7], 0 offen sc1
    v_mfma_f32_16x16x32_bf16 v[84:87], a[200:203], v[112:115], v[84:87]
    s_add_u32 s49, s46, 9216
    v_mfma_f32_16x16x32_bf16 v[84:87], a[212:215], v[116:119], v[84:87]
    v_mfma_f32_16x16x32_bf16 v[84:87], a[224:227], v[120:123], v[84:87]
    buffer_load_dwordx4 a[36:39], v3, s[4:7], s49 offen offset:0 sc1
    v_mfma_f32_16x16x32_bf16 v[84:87], a[236:239], v[124:127], v[84:87]
    s_waitcnt vmcnt(12)
    ds_read_b128 a[48:51], v31 offset:0
    v_mfma_f32_16x16x32_bf16 v[88:91], v[132:135], a[240:243], 0
    ds_read_b128 a[52:55], v31 offset:1024
    v_mfma_f32_16x16x32_bf16 v[88:91], v[152:155], a[244:247], v[88:91]
    s_waitcnt lgkmcnt(2)
    v_fmac_f32 v76, v56, v4
    v_fmac_f32 v77, v56, v5
    v_mfma_f32_16x16x32_bf16 v[88:91], v[172:175], a[248:251], v[88:91]
    ds_read_b128 a[56:59], v31 offset:2048
    v_fmac_f32 v80, v56, v8
    v_mfma_f32_16x16x32_bf16 v[88:91], v[192:195], a[252:255], v[88:91]
    buffer_load_dwordx4 a[40:43], v3, s[4:7], s49 offen offset:1024 sc1
    v_mfma_f32_16x16x32_bf16 v[88:91], v[212:215], v[128:131], v[88:91]
    v_fmac_f32 v81, v56, v9
    v_fmac_f32 v84, v56, v12
    v_mfma_f32_16x16x32_bf16 v[88:91], v[232:235], v[52:55], v[88:91]
L_hop5:
    s_cbranch_execz L_hopret
    v_fmac_f32 v85, v56, v13
    v_mul_f32 v36, v57, v76
    v_mfma_f32_16x16x32_bf16 v[92:95], v[136:139], a[240:243], 0
    ds_read_b128 a[60:63], v31 offset:3072
    v_mul_f32 v37, v57, v77
    v_mfma_f32_16x16x32_bf16 v[92:95], v[156:159], a[244:247], v[92:95]
    buffer_load_dwordx4 a[44:47], v3, s[4:7], s49 offen offset:2048 sc1
    v_mul_f32 v38, v57, v80
    v_mfma_f32_16x16x32_bf16 v[92:95], v[176:179], a[248:251], v[92:95]
    v_mul_f32 v39, v57, v81
    v_mul_f32 v40, v57, v84
    v_mul_f32 v41, v57, v85
    v_mfma_f32_16x16x32_bf16 v[92:95], v[196:199], a[252:255], v[92:95]
    s_add_u32 s49, s46, 55296
    ds_read_b128 a[64:67], v31 offset:4096
    v_exp_f32 v36, v36
    v_mfma_f32_16x16x32_bf16 v[92:95], v[216:219], v[128:131], v[92:95]
    v_exp_f32 v37, v37
    v_mfma_f32_16x16x32_bf16 v[92:95], v[236:239], v[52:55], v[92:95]
    ds_read_b128 a[68:71], v31 offset:5120
    v_exp_f32 v38, v38
    v_mfma_f32_16x16x32_bf16 v[96:99], v[140:143], a[240:243], 0
    v_exp_f32 v39, v39
    v_mfma_f32_16x16x32_bf16 v[96:99], v[160:163], a[244:247], v[96:99]
    buffer_load_dwordx4 a[180:183], v3, s[4:7], s49 offen offset:0 sc1
    ds_read_b128 a[72:75], v31 offset:6144
    v_mfma_f32_16x16x32_bf16 v[96:99], v[180:183], a[248:251], v[96:99]
    v_exp_f32 v40, v40
    v_mfma_f32_16x16x32_bf16 v[96:99], v[200:203], a[252:255], v[96:99]
    v_exp_f32 v41, v41
    v_fmac_f32 v78, v56, v6
    v_mfma_f32_16x16x32_bf16 v[96:99], v[220:223], v[128:131], v[96:99]
    v_fmac_f32 v79, v56, v7
    v_fmac_f32 v82, v56, v10
    v_fmac_f32 v83, v56, v11
    v_mfma_f32_16x16x32_bf16 v[96:99], v[240:243], v[52:55], v[96:99]
    ds_read_b128 a[76:79], v31 offset:7168
    v_fmac_f32 v86, v56, v14
    v_fmac_f32 v87, v56, v15
    v_mfma_f32_16x16x32_bf16 v[100:103], v[144:147], a[240:243], 0
    buffer_load_dwordx4 a[184:187], v3, s[4:7], s49 offen offset:1024 sc1
    v_mul_f32 v42, v76, v78
    v_mfma_f32_16x16x32_bf16 v[100:103], v[164:167], a[244:247], v[100:103]
    ds_read_b128 a[80:83], v31 offset:8192
    v_mul_f32 v43, v77, v79
    v_mul_f32 v44, v80, v82
    v_mfma_f32_16x16x32_bf16 v[100:103], v[184:187], a[248:251], v[100:103]
    v_mul_f32 v45, v81, v83
    v_mul_f32 v46, v84, v86
    v_mul_f32 v47, v85, v87
    v_mfma_f32_16x16x32_bf16 v[100:103], v[204:207], a[252:255], v[100:103]
    ds_read_b128 a[84:87], v31 offset:9216
    v_add_f32 v36, 1.0, v36
    v_add_f32 v37, 1.0, v37
    v_mfma_f32_16x16x32_bf16 v[100:103], v[224:227], v[128:131], v[100:103]
    v_add_f32 v38, 1.0, v38
    v_add_f32 v39, 1.0, v39
    v_add_f32 v40, 1.0, v40
    v_mfma_f32_16x16x32_bf16 v[100:103], v[244:247], v[52:55], v[100:103]
    buffer_load_dwordx4 a[188:191], v3, s[4:7], s49 offen offset:2048 sc1
    v_add_f32 v41, 1.0, v41
    v_mfma_f32_16x16x32_bf16 v[104:107], v[148:151], a[240:243], 0
    s_add_u32 s49, s46, 58368
    ds_read_b128 a[88:91], v31 offset:10240
    v_rcp_f32 v36, v36
    v_mfma_f32_16x16x32_bf16 v[104:107], v[168:171], a[244:247], v[104:107]
    ds_read_b128 a[92:95], v31 offset:11264
    v_rcp_f32 v37, v37
    v_mfma_f32_16x16x32_bf16 v[104:107], v[188:191], a[248:251], v[104:107]
    ds_read_b128 a[96:99], v31 offset:12288
    v_rcp_f32 v38, v38
    v_mfma_f32_16x16x32_bf16 v[104:107], v[208:211], a[252:255], v[104:107]
    ds_read_b128 a[100:103], v31 offset:13312
    v_rcp_f32 v39, v39
    v_mfma_f32_16x16x32_bf16 v[104:107], v[228:231], v[128:131], v[104:107]
    ds_read_b128 a[104:107], v31 offset:14336
    v_rcp_f32 v40, v40
    v_mfma_f32_16x16x32_bf16 v[104:107], v[248:251], v[52:55], v[104:107]
    s_waitcnt vmcnt(11)
    v_rcp_f32 v41, v41
    v_mul_f32 v42, v42, v36
    v_mfma_f32_16x16x32_bf16 v[108:111], v[132:135], a[0:3], 0
    buffer_load_dwordx4 a[192:195], v3, s[4:7], s49 offen offset:0 sc1
    v_mul_f32 v43, v43, v37
    v_mfma_f32_16x16x32_bf16 v[108:111], v[152:155], a[4:7], v[108:111]
    v_mul_f32 v44, v44, v38
    v_mul_f32 v45, v45, v39
    v_mul_f32 v46, v46, v40
    v_mfma_f32_16x16x32_bf16 v[108:111], v[172:175], a[8:11], v[108:111]
    v_mul_f32 v47, v47, v41
    v_cvt_pk_bf16_f32 v48, v42, v43
    v_cvt_pk_bf16_f32 v50, v46, v47
    v_mfma_f32_16x16x32_bf16 v[108:111], v[192:195], a[12:15], v[108:111]
    buffer_load_dword v30, v26, s[4:7], 0 offen sc1
    v_cvt_pk_bf16_f32 v49, v44, v45
    v_mfma_f32_16x16x32_bf16 v[108:111], v[212:215], a[16:19], v[108:111]
    s_add_u32 s45, s43, 344064
    ds_read_b128 a[108:111], v31 offset:15360
    v_permlane32_swap_b32 v48, v50
    v_mfma_f32_16x16x32_bf16 v[108:111], v[232:235], a[20:23], v[108:111]
    ds_read_b128 a[112:115], v31 offset:16384
    v_permlane32_swap_b32 v49, v51
    v_mfma_f32_16x16x32_bf16 v[112:115], v[136:139], a[0:3], 0
    ds_read_b128 a[116:119], v31 offset:17408
    v_permlane16_swap_b32 v48, v49
    v_mfma_f32_16x16x32_bf16 v[112:115], v[156:159], a[4:7], v[112:115]
    ds_read_b128 a[120:123], v31 offset:18432
    v_permlane16_swap_b32 v50, v51
    v_mfma_f32_16x16x32_bf16 v[112:115], v[176:179], a[8:11], v[112:115]
    buffer_store_dwordx4 v[48:51], v33, s[4:7], s45 offen sc1
    v_mfma_f32_16x16x32_bf16 v[112:115], v[196:199], a[12:15], v[112:115]
    buffer_load_dwordx4 a[196:199], v3, s[4:7], s49 offen offset:1024 sc1
    ds_read_b128 a[124:127], v35 offset:40960
    v_mfma_f32_16x16x32_bf16 v[112:115], v[216:219], a[16:19], v[112:115]
    buffer_load_dwordx4 a[200:203], v3, s[4:7], s49 offen offset:2048 sc1
    ds_read_b128 a[128:131], v35 offset:41984
    v_mfma_f32_16x16x32_bf16 v[112:115], v[236:239], a[20:23], v[112:115]
    ds_read_b128 a[132:135], v35 offset:43008
    ds_read_b128 a[136:139], v35 offset:44032
    v_mfma_f32_16x16x32_bf16 v[116:119], v[140:143], a[0:3], 0
    ds_read_b128 a[140:143], v35 offset:45056
    v_mfma_f32_16x16x32_bf16 v[116:119], v[160:163], a[4:7], v[116:119]
    v_mfma_f32_16x16x32_bf16 v[116:119], v[180:183], a[8:11], v[116:119]
    ds_read_b128 a[144:147], v35 offset:0
    v_mfma_f32_16x16x32_bf16 v[116:119], v[200:203], a[12:15], v[116:119]
    v_mfma_f32_16x16x32_bf16 v[116:119], v[220:223], a[16:19], v[116:119]
    ds_read_b128 a[148:151], v35 offset:1024
    v_mfma_f32_16x16x32_bf16 v[116:119], v[240:243], a[20:23], v[116:119]
    v_mfma_f32_16x16x32_bf16 v[120:123], v[144:147], a[0:3], 0
    ds_read_b128 a[152:155], v35 offset:2048
    v_mfma_f32_16x16x32_bf16 v[120:123], v[164:167], a[4:7], v[120:123]
    v_mfma_f32_16x16x32_bf16 v[120:123], v[184:187], a[8:11], v[120:123]
    ds_read_b128 a[156:159], v35 offset:3072
    v_mfma_f32_16x16x32_bf16 v[120:123], v[204:207], a[12:15], v[120:123]
    v_mfma_f32_16x16x32_bf16 v[120:123], v[224:227], a[16:19], v[120:123]
    ds_read_b128 a[160:163], v35 offset:4096
    v_mfma_f32_16x16x32_bf16 v[120:123], v[244:247], a[20:23], v[120:123]
    v_mfma_f32_16x16x32_bf16 v[124:127], v[148:151], a[0:3], 0
    v_mfma_f32_16x16x32_bf16 v[124:127], v[168:171], a[4:7], v[124:127]
    v_mfma_f32_16x16x32_bf16 v[124:127], v[188:191], a[8:11], v[124:127]
    v_mfma_f32_16x16x32_bf16 v[124:127], v[208:211], a[12:15], v[124:127]
    v_mfma_f32_16x16x32_bf16 v[124:127], v[228:231], a[16:19], v[124:127]
    v_mfma_f32_16x16x32_bf16 v[124:127], v[248:251], a[20:23], v[124:127]
    s_waitcnt vmcnt(8) lgkmcnt(0)
    v_mfma_f32_16x16x32_bf16 v[88:91], v[252:255], a[24:27], v[88:91]
    v_mfma_f32_16x16x32_bf16 v[88:91], a[64:67], a[28:31], v[88:91]
    v_mfma_f32_16x16x32_bf16 v[88:91], a[84:87], a[32:35], v[88:91]
    v_mfma_f32_16x16x32_bf16 v[88:91], a[104:107], a[36:39], v[88:91]
    v_mfma_f32_16x16x32_bf16 v[88:91], a[124:127], a[40:43], v[88:91]
    v_mfma_f32_16x16x32_bf16 v[88:91], a[144:147], a[44:47], v[88:91]
    v_mfma_f32_16x16x32_bf16 v[92:95], a[48:51], a[24:27], v[92:95]
    s_waitcnt vmcnt(3)
    v_mfma_f32_16x16x32_bf16 v[92:95], a[68:71], a[28:31], v[92:95]
    v_mfma_f32_16x16x32_bf16 v[92:95], a[88:91], a[32:35], v[92:95]
    v_subrev_u32 v30, s34, v30
    v_cmp_lt_u32 vcc, 1, v30
    v_mfma_f32_16x16x32_bf16 v[92:95], a[108:111], a[36:39], v[92:95]
    s_cbranch_vccnz L_slow6
L_back6:
    s_add_u32 s49, s46, 98304
    v_mfma_f32_16x16x32_bf16 v[92:95], a[128:131], a[40:43], v[92:95]
    buffer_load_dwordx4 a[204:207], v3, s[4:7], s49 offen offset:0 sc1
    v_mfma_f32_16x16x32_bf16 v[92:95], a[148:151], a[44:47], v[92:95]
    v_mfma_f32_16x16x32_bf16 v[96:99], a[52:55], a[24:27], v[96:99]
    buffer_load_dwordx4 a[208:211], v3, s[4:7], s49 offen offset:1024 sc1
    v_mfma_f32_16x16x32_bf16 v[96:99], a[72:75], a[28:31], v[96:99]
    v_mfma_f32_16x16x32_bf16 v[96:99], a[92:95], a[32:35], v[96:99]
    v_mfma_f32_16x16x32_bf16 v[96:99], a[112:115], a[36:39], v[96:99]
    v_mfma_f32_16x16x32_bf16 v[96:99], a[132:135], a[40:43], v[96:99]
    buffer_load_dwordx4 a[212:215], v3, s[4:7], s49 offen offset:2048 sc1
    v_mfma_f32_16x16x32_bf16 v[96:99], a[152:155], a[44:47], v[96:99]
    v_mfma_f32_16x16x32_bf16 v[100:103], a[56:59], a[24:27], v[100:103]
    s_add_u32 s49, s46, 101376
    v_mfma_f32_16x16x32_bf16 v[100:103], a[76:79], a[28:31], v[100:103]
    v_mfma_f32_16x16x32_bf16 v[100:103], a[96:99], a[32:35], v[100:103]
    buffer_load_dwordx4 a[216:219], v3, s[4:7], s49 offen offset:0 sc1
    v_mfma_f32_16x16x32_bf16 v[100:103], a[116:119], a[36:39], v[100:103]
    s_waitcnt vmcnt(6)
    s_barrier
    v_mfma_f32_16x16x32_bf16 v[100:103], a[136:139], a[40:43], v[100:103]
    v_add_u32 v29, 1, v29
    v_mfma_f32_16x16x32_bf16 v[100:103], a[156:159], a[44:47], v[100:103]
    buffer_store_dword v29, v27, s[4:7], 0 offen sc1
    v_mfma_f32_16x16x32_bf16 v[104:107], a[60:63], a[24:27], v[104:107]
    v_mfma_f32_16x16x32_bf16 v[104:107], a[80:83], a[28:31], v[104:107]
    buffer_load_dwordx4 a[220:223], v3, s[4:7], s49 offen offset:1024 sc1
    v_mfma_f32_16x16x32_bf16 v[104:107], a[100:103], a[32:35], v[104:107]
    v_mfma_f32_16x16x32_bf16 v[104:107], a[120:123], a[36:39], v[104:107]
    ds_write_b128 v20, v[88:91] offset:0
    v_mfma_f32_16x16x32_bf16 v[104:107], a[140:143], a[40:43], v[104:107]
    v_mfma_f32_16x16x32_bf16 v[104:107], a[160:163], a[44:47], v[104:107]
    s_waitcnt vmcnt(6)
    ds_write_b128 v20, v[92:95] offset:64
    v_mfma_f32_16x16x32_bf16 v[108:111], v[252:255], a[180:183], v[108:111]
    buffer_load_dwordx4 a[224:227], v3, s[4:7], s49 offen offset:2048 sc1
    v_mfma_f32_16x16x32_bf16 v[108:111], a[64:67], a[184:187], v[108:111]
    s_add_u32 s49, s46, 104448
    ds_write_b128 v20, v[96:99] offset:128
    v_mfma_f32_16x16x32_bf16 v[108:111], a[84:87], a[188:191], v[108:111]
    v_mfma_f32_16x16x32_bf16 v[108:111], a[104:107], a[192:195], v[108:111]
    buffer_load_dwordx4 a[240:243], v3, s[4:7], s49 offen offset:0 sc1
    v_mfma_f32_16x16x32_bf16 v[108:111], a[124:127], a[196:199], v[108:111]
    ds_write_b128 v20, v[100:103] offset:192
    v_mfma_f32_16x16x32_bf16 v[108:111], a[144:147], a[200:203], v[108:111]
    ds_write_b128 v20, v[104:107] offset:256
    v_mfma_f32_16x16x32_bf16 v[112:115], a[48:51], a[180:183], v[112:115]
    v_mfma_f32_16x16x32_bf16 v[112:115], a[68:71], a[184:187], v[112:115]
    v_mfma_f32_16x16x32_bf16 v[112:115], a[88:91], a[188:191], v[112:115]
    buffer_load_dwordx4 a[244:247], v3, s[4:7], s49 offen offset:1024 sc1
    v_mfma_f32_16x16x32_bf16 v[112:115], a[108:111], a[192:195], v[112:115]
    s_nop 1
    ds_write_b128 v20, v[108:111] offset:21504
    v_mfma_f32_16x16x32_bf16 v[112:115], a[128:131], a[196:199], v[112:115]
    s_waitcnt lgkmcnt(0)
    s_barrier
    v_mfma_f32_16x16x32_bf16 v[112:115], a[148:151], a[200:203], v[112:115]
    v_mfma_f32_16x16x32_bf16 v[116:119], a[52:55], a[180:183], v[116:119]
    buffer_load_dwordx4 a[248:251], v3, s[4:7], s49 offen offset:2048 sc1
    v_mfma_f32_16x16x32_bf16 v[116:119], a[72:75], a[184:187], v[116:119]
    ds_read_b32 v36, v23 offset:0
    ds_read_b128 v[4:7], v21 offset:0
    v_mfma_f32_16x16x32_bf16 v[116:119], a[92:95], a[188:191], v[116:119]
    s_add_u32 s49, s46, 107520
    ds_read_b128 v[8:11], v21 offset:16
    v_mfma_f32_16x16x32_bf16 v[116:119], a[112:115], a[192:195], v[116:119]
    ds_read_b128 v[12:15], v21 offset:5376
    v_mfma_f32_16x16x32_bf16 v[116:119], a[132:135], a[196:199], v[116:119]
    buffer_load_dwordx4 a[252:255], v3, s[4:7], s49 offen offset:0 sc1
    v_mfma_f32_16x16x32_bf16 v[116:119], a[152:155], a[200:203], v[116:119]
    ds_write_b128 v20, v[112:115] offset:21568
    v_mfma_f32_16x16x32_bf16 v[120:123], a[56:59], a[180:183], v[120:123]
    ds_read_b128 v[16:19], v21 offset:5392
    ds_read_b128 v[64:67], v21 offset:10752
    v_mfma_f32_16x16x32_bf16 v[120:123], a[76:79], a[184:187], v[120:123]
    ds_read_b128 v[68:71], v21 offset:10768
    ds_read_b128 v[72:75], v21 offset:16128
    v_mfma_f32_16x16x32_bf16 v[120:123], a[96:99], a[188:191], v[120:123]
    buffer_load_dwordx4 v[128:131], v3, s[4:7], s49 offen offset:1024 sc1
    v_mfma_f32_16x16x32_bf16 v[120:123], a[116:119], a[192:195], v[120:123]
    ds_read_b128 v[76:79], v21 offset:16144
    ds_read_b128 v[80:83], v22 offset:0
    v_mfma_f32_16x16x32_bf16 v[120:123], a[136:139], a[196:199], v[120:123]
    ds_read_b128 v[84:87], v22 offset:16
    v_mfma_f32_16x16x32_bf16 v[120:123], a[156:159], a[200:203], v[120:123]
    ds_write_b128 v20, v[116:119] offset:21632
    v_mfma_f32_16x16x32_bf16 v[124:127], a[60:63], a[180:183], v[124:127]
    v_mfma_f32_16x16x32_bf16 v[124:127], a[80:83], a[184:187], v[124:127]
    buffer_load_dword v30, v26, s[4:7], 0 offen sc1
    v_mfma_f32_16x16x32_bf16 v[124:127], a[100:103], a[188:191], v[124:127]
    v_mfma_f32_16x16x32_bf16 v[124:127], a[120:123], a[192:195], v[124:127]
    s_nop 1
    ds_write_b128 v20, v[120:123] offset:21696
    v_mfma_f32_16x16x32_bf16 v[124:127], a[140:143], a[196:199], v[124:127]
    s_waitcnt lgkmcnt(2)
    v_add_f32 v4, v4, v12
    v_add_f32 v5, v5, v13
    v_mfma_f32_16x16x32_bf16 v[124:127], a[160:163], a[200:203], v[124:127]
    s_waitcnt vmcnt(6)
    v_add_f32 v6, v6, v14
    v_add_f32 v7, v7, v15
    v_mfma_f32_16x16x32_bf16 v[88:91], v[132:135], a[204:207], 0
    buffer_load_dwordx4 v[52:55], v3, s[4:7], s49 offen offset:2048 sc1
    v_mfma_f32_16x16x32_bf16 v[88:91], v[152:155], a[208:211], v[88:91]
    v_add_f32 v8, v8, v16
    v_add_f32 v9, v9, v17
    v_mfma_f32_16x16x32_bf16 v[88:91], v[172:175], a[212:215], v[88:91]
    v_add_f32 v10, v10, v18
    v_add_f32 v11, v11, v19
    v_mfma_f32_16x16x32_bf16 v[88:91], v[192:195], a[216:219], v[88:91]
    v_add_f32 v64, v64, v72
    v_add_f32 v65, v65, v73
    v_mfma_f32_16x16x32_bf16 v[88:91], v[212:215], a[220:223], v[88:91]
    ds_write_b128 v20, v[124:127] offset:21760
    v_mfma_f32_16x16x32_bf16 v[88:91], v[232:235], a[224:227], v[88:91]
    v_add_f32 v66, v66, v74
    v_add_f32 v67, v67, v75
    v_mfma_f32_16x16x32_bf16 v[92:95], v[136:139], a[204:207], 0
    v_add_f32 v68, v68, v76
    v_add_f32 v69, v69, v77
    v_mfma_f32_16x16x32_bf16 v[92:95], v[156:159], a[208:211], v[92:95]
    v_add_f32 v70, v70, v78
    v_add_f32 v71, v71, v79
    v_mfma_f32_16x16x32_bf16 v[92:95], v[176:179], a[212:215], v[92:95]
    v_add_f32 v4, v4, v64
    v_add_f32 v5, v5, v65
    v_mfma_f32_16x16x32_bf16 v[92:95], v[196:199], a[216:219], v[92:95]
    v_add_f32 v6, v6, v66
    v_add_f32 v7, v7, v67
    v_mfma_f32_16x16x32_bf16 v[92:95], v[216:219], a[220:223], v[92:95]
    v_add_f32 v8, v8, v68
    v_add_f32 v9, v9, v69
    v_mfma_f32_16x16x32_bf16 v[92:95], v[236:239], a[224:227], v[92:95]
    v_add_f32 v10, v10, v70
    v_add_f32 v11, v11, v71
    v_mfma_f32_16x16x32_bf16 v[96:99], v[140:143], a[204:207], 0
    v_fma_f32 v4, v4, v36, v80
    v_mfma_f32_16x16x32_bf16 v[96:99], v[160:163], a[208:211], v[96:99]
    v_fma_f32 v5, v5, v36, v81
    v_fma_f32 v6, v6, v36, v82
    v_mfma_f32_16x16x32_bf16 v[96:99], v[180:183], a[212:215], v[96:99]
    v_fma_f32 v7, v7, v36, v83
    v_fma_f32 v8, v8, v36, v84
    v_mfma_f32_16x16x32_bf16 v[96:99], v[200:203], a[216:219], v[96:99]
    v_fma_f32 v9, v9, v36, v85
    v_mfma_f32_16x16x32_bf16 v[96:99], v[220:223], a[220:223], v[96:99]
    v_fma_f32 v10, v10, v36, v86
    v_fma_f32 v11, v11, v36, v87
    v_mfma_f32_16x16x32_bf16 v[96:99], v[240:243], a[224:227], v[96:99]
    v_cvt_pk_bf16_f32 v40, v4, v5
    v_cvt_pk_bf16_f32 v41, v6, v7
    v_mfma_f32_16x16x32_bf16 v[100:103], v[144:147], a[204:207], 0
    v_cvt_pk_bf16_f32 v42, v8, v9
    v_mfma_f32_16x16x32_bf16 v[100:103], v[164:167], a[208:211], v[100:103]
    v_cvt_pk_bf16_f32 v43, v10, v11
    v_mfma_f32_16x16x32_bf16 v[100:103], v[184:187], a[212:215], v[100:103]
    s_add_u32 s45, s47, 0
    buffer_store_dwordx4 v[40:43], v25, s[8:11], s45 offen nt
    v_mfma_f32_16x16x32_bf16 v[100:103], v[204:207], a[216:219], v[100:103]
    v_mfma_f32_16x16x32_bf16 v[100:103], v[224:227], a[220:223], v[100:103]
    s_waitcnt lgkmcnt(0)
    s_barrier
    v_mfma_f32_16x16x32_bf16 v[100:103], v[244:247], a[224:227], v[100:103]
    v_mfma_f32_16x16x32_bf16 v[104:107], v[148:151], a[204:207], 0
    ds_read_b32 v36, v23 offset:256
    v_mfma_f32_16x16x32_bf16 v[104:107], v[168:171], a[208:211], v[104:107]
    ds_read_b128 v[4:7], v21 offset:21504
    v_mfma_f32_16x16x32_bf16 v[104:107], v[188:191], a[212:215], v[104:107]
    ds_read_b128 v[8:11], v21 offset:21520
    v_mfma_f32_16x16x32_bf16 v[104:107], v[208:211], a[216:219], v[104:107]
    ds_read_b128 v[12:15], v21 offset:26880
    v_mfma_f32_16x16x32_bf16 v[104:107], v[228:231], a[220:223], v[104:107]
    ds_read_b128 v[16:19], v21 offset:26896
    v_mfma_f32_16x16x32_bf16 v[104:107], v[248:251], a[224:227], v[104:107]
    s_waitcnt vmcnt(1)
    ds_read_b128 v[64:67], v21 offset:32256
    v_mfma_f32_16x16x32_bf16 v[88:91], v[252:255], a[240:243], v[88:91]
    ds_read_b128 v[68:71], v21 offset:32272
    v_mfma_f32_16x16x32_bf16 v[88:91], a[64:67], a[244:247], v[88:91]
    ds_read_b128 v[72:75], v21 offset:37632
    v_mfma_f32_16x16x32_bf16 v[88:91], a[84:87], a[248:251], v[88:91]
    ds_read_b128 v[76:79], v21 offset:37648
    v_mfma_f32_16x16x32_bf16 v[88:91], a[104:107], a[252:255], v[88:91]
    ds_read_b128 v[80:83], v22 offset:5376
    v_mfma_f32_16x16x32_bf16 v[88:91], a[124:127], v[128:131], v[88:91]
    ds_read_b128 v[84:87], v22 offset:5392
    v_subrev_u32 v30, s35, v30
    v_mfma_f32_16x16x32_bf16 v[88:91], a[144:147], v[52:55], v[88:91]
    v_cmp_lt_u32 vcc, 0, v30
    v_mfma_f32_16x16x32_bf16 v[92:95], a[48:51], a[240:243], v[92:95]
    s_cbranch_vccnz L_slow7
L_back7:
    s_add_u32 s49, s46, 147456
    v_mfma_f32_16x16x32_bf16 v[92:95], a[68:71], a[244:247], v[92:95]
    buffer_load_dwordx4 a[0:3], v3, s[4:7], s49 offen offset:0 sc1
    v_mfma_f32_16x16x32_bf16 v[92:95], a[88:91], a[248:251], v[92:95]
    buffer_load_dwordx4 a[4:7], v3, s[4:7], s49 offen offset:1024 sc1
    v_mfma_f32_16x16x32_bf16 v[92:95], a[108:111], a[252:255], v[92:95]
    ds_write_b128 v20, v[88:91] offset:0
    v_mfma_f32_16x16x32_bf16 v[92:95], a[128:131], v[128:131], v[92:95]
    s_waitcnt lgkmcnt(1)
    v_add_f32 v4, v4, v12
    v_add_f32 v5, v5, v13
    v_mfma_f32_16x16x32_bf16 v[92:95], a[148:151], v[52:55], v[92:95]
    v_add_f32 v6, v6, v14
    v_add_f32 v7, v7, v15
    v_mfma_f32_16x16x32_bf16 v[96:99], a[52:55], a[240:243], v[96:99]
    buffer_load_dwordx4 a[8:11], v3, s[4:7], s49 offen offset:2048 sc1
    v_mfma_f32_16x16x32_bf16 v[96:99], a[72:75], a[244:247], v[96:99]
    v_add_f32 v8, v8, v16
    v_add_f32 v9, v9, v17
    v_mfma_f32_16x16x32_bf16 v[96:99], a[92:95], a[248:251], v[96:99]
    s_add_u32 s49, s46, 150528
    v_add_f32 v10, v10, v18
    v_add_f32 v11, v11, v19
    v_mfma_f32_16x16x32_bf16 v[96:99], a[112:115], a[252:255], v[96:99]
    v_add_f32 v64, v64, v72
    v_add_f32 v65, v65, v73
    v_mfma_f32_16x16x32_bf16 v[96:99], a[132:135], v[128:131], v[96:99]
    buffer_load_dwordx4 a[12:15], v3, s[4:7], s49 offen offset:0 sc1
    v_mfma_f32_16x16x32_bf16 v[96:99], a[152:155], v[52:55], v[96:99]
    ds_write_b128 v20, v[92:95] offset:64
    v_mfma_f32_16x16x32_bf16 v[100:103], a[56:59], a[240:243], v[100:103]
    v_add_f32 v66, v66, v74
    v_add_f32 v67, v67, v75
    v_mfma_f32_16x16x32_bf16 v[100:103], a[76:79], a[244:247], v[100:103]
    v_add_f32 v68, v68, v76
    v_add_f32 v69, v69, v77
    v_mfma_f32_16x16x32_bf16 v[100:103], a[96:99], a[248:251], v[100:103]
    buffer_load_dwordx4 a[16:19], v3, s[4:7], s49 offen offset:1024 sc1
    v_mfma_f32_16x16x32_bf16 v[100:103], a[116:119], a[252:255], v[100:103]
    v_add_f32 v70, v70, v78
    v_add_f32 v71, v71, v79
    v_mfma_f32_16x16x32_bf16 v[100:103], a[136:139], v[128:131], v[100:103]
    v_add_f32 v4, v4, v64
    v_add_f32 v5, v5, v65
    v_mfma_f32_16x16x32_bf16 v[100:103], a[156:159], v[52:55], v[100:103]
    ds_write_b128 v20, v[96:99] offset:128
    v_mfma_f32_16x16x32_bf16 v[104:107], a[60:63], a[240:243], v[104:107]
    v_add_f32 v6, v6, v66
    v_add_f32 v7, v7, v67
    v_mfma_f32_16x16x32_bf16 v[104:107], a[80:83], a[244:247], v[104:107]
    buffer_load_dwordx4 a[20:23], v3, s[4:7], s49 offen offset:2048 sc1
    v_add_f32 v8, v8, v68
    v_mfma_f32_16x16x32_bf16 v[104:107], a[100:103], a[248:251], v[104:107]
    s_add_u32 s49, s46, 153600
    v_add_f32 v9, v9, v69
    v_add_f32 v10, v10, v70
    v_mfma_f32_16x16x32_bf16 v[104:107], a[120:123], a[252:255], v[104:107]
    v_add_f32 v11, v11, v71
    v_fma_f32 v4, v4, v36, v80
    v_mfma_f32_16x16x32_bf16 v[104:107], a[140:143], v[128:131], v[104:107]
    buffer_load_dwordx4 a[24:27], v3, s[4:7], s49 offen offset:0 sc1
    v_fma_f32 v5, v5, v36, v81
    v_mfma_f32_16x16x32_bf16 v[104:107], a[160:163], v[52:55], v[104:107]
    s_waitcnt vmcnt(5)
    ds_write_b128 v20, v[100:103] offset:192
    v_mfma_f32_16x16x32_bf16 v[108:111], v[132:135], a[0:3], 0
    v_fma_f32 v6, v6, v36, v82
    v_fma_f32 v7, v7, v36, v83
    v_fma_f32 v8, v8, v36, v84
    v_mfma_f32_16x16x32_bf16 v[108:111], v[152:155], a[4:7], v[108:111]
    v_fma_f32 v9, v9, v36, v85
    v_fma_f32 v10, v10, v36, v86
    v_mfma_f32_16x16x32_bf16 v[112:115], v[136:139], a[0:3], 0
    v_fma_f32 v11, v11, v36, v87
    v_cvt_pk_bf16_f32 v44, v4, v5
    v_cvt_pk_bf16_f32 v45, v6, v7
    v_cvt_pk_bf16_f32 v46, v8, v9
    v_cvt_pk_bf16_f32 v47, v10, v11
    s_add_u32 s45, s47, 40960
    buffer_store_dwordx4 v[44:47], v25, s[8:11], s45 offen nt
    v_mfma_f32_16x16x32_bf16 v[112:115], v[156:159], a[4:7], v[112:115]
    buffer_load_dwordx4 a[28:31], v3, s[4:7], s49 offen offset:1024 sc1
    v_mfma_f32_16x16x32_bf16 v[116:119], v[140:143], a[0:3], 0
    ds_write_b128 v20, v[104:107] offset:256
    v_mfma_f32_16x16x32_bf16 v[116:119], v[160:163], a[4:7], v[116:119]
    v_mfma_f32_16x16x32_bf16 v[120:123], v[144:147], a[0:3], 0
    buffer_load_dwordx4 a[32:35], v3, s[4:7], s49 offen offset:2048 sc1
    v_mfma_f32_16x16x32_bf16 v[120:123], v[164:167], a[4:7], v[120:123]
    v_mfma_f32_16x16x32_bf16 v[124:127], v[148:151], a[0:3], 0
    s_add_u32 s49, s46, 156672
    v_mfma_f32_16x16x32_bf16 v[124:127], v[168:171], a[4:7], v[124:127]
    s_waitcnt vmcnt(6)
    v_mfma_f32_16x16x32_bf16 v[108:111], v[172:175], a[8:11], v[108:111]
    buffer_load_dwordx4 a[36:39], v3, s[4:7], s49 offen offset:0 sc1
    v_mfma_f32_16x16x32_bf16 v[108:111], v[192:195], a[12:15], v[108:111]
    s_waitcnt lgkmcnt(0)
    s_barrier
    v_mfma_f32_16x16x32_bf16 v[112:115], v[176:179], a[8:11], v[112:115]
    ds_read_b32 v36, v23 offset:512
    v_mfma_f32_16x16x32_bf16 v[112:115], v[196:199], a[12:15], v[112:115]
    ds_read_b128 v[4:7], v21 offset:0
    v_mfma_f32_16x16x32_bf16 v[116:119], v[180:183], a[8:11], v[116:119]
    buffer_load_dwordx4 a[40:43], v3, s[4:7], s49 offen offset:1024 sc1
    v_mfma_f32_16x16x32_bf16 v[116:119], v[200:203], a[12:15], v[116:119]
    ds_read_b128 v[8:11], v21 offset:16
    ds_read_b128 v[12:15], v21 offset:5376
    v_mfma_f32_16x16x32_bf16 v[120:123], v[184:187], a[8:11], v[120:123]
    ds_read_b128 v[16:19], v21 offset:5392
    v_mfma_f32_16x16x32_bf16 v[120:123], v[204:207], a[12:15], v[120:123]
    ds_read_b128 v[64:67], v21 offset:10752
    v_mfma_f32_16x16x32_bf16 v[124:127], v[188:191], a[8:11], v[124:127]
    buffer_load_dwordx4 a[44:47], v3, s[4:7], s49 offen offset:2048 sc1
    v_mfma_f32_16x16x32_bf16 v[124:127], v[208:211], a[12:15], v[124:127]
    s_waitcnt vmcnt(7)
    ds_read_b128 v[68:71], v21 offset:10768
    ds_read_b128 v[72:75], v21 offset:16128
    v_mfma_f32_16x16x32_bf16 v[108:111], v[212:215], a[16:19], v[108:111]
    ds_read_b128 v[76:79], v21 offset:16144
    v_mfma_f32_16x16x32_bf16 v[108:111], v[232:235], a[20:23], v[108:111]
    ds_read_b128 v[80:83], v22 offset:10752
    v_mfma_f32_16x16x32_bf16 v[112:115], v[216:219], a[16:19], v[112:115]
    ds_read_b128 v[84:87], v22 offset:10768
    v_mfma_f32_16x16x32_bf16 v[112:115], v[236:239], a[20:23], v[112:115]
    v_mfma_f32_16x16x32_bf16 v[116:119], v[220:223], a[16:19], v[116:119]
    v_mfma_f32_16x16x32_bf16 v[116:119], v[240:243], a[20:23], v[116:119]
    v_mfma_f32_16x16x32_bf16 v[120:123], v[224:227], a[16:19], v[120:123]
    v_mfma_f32_16x16x32_bf16 v[120:123], v[244:247], a[20:23], v[120:123]
    v_mfma_f32_16x16x32_bf16 v[124:127], v[228:231], a[16:19], v[124:127]
    s_waitcnt lgkmcnt(0)
    v_add_f32 v4, v4, v12
    v_add_f32 v5, v5, v13
    v_mfma_f32_16x16x32_bf16 v[124:127], v[248:251], a[20:23], v[124:127]
    s_waitcnt vmcnt(0)
    v_add_f32 v6, v6, v14
    v_mfma_f32_16x16x32_bf16 v[108:111], v[252:255], a[24:27], v[108:111]
    v_add_f32 v7, v7, v15
    v_add_f32 v8, v8, v16
    v_mfma_f32_16x16x32_bf16 v[108:111], a[64:67], a[28:31], v[108:111]
    v_add_f32 v9, v9, v17
    v_mfma_f32_16x16x32_bf16 v[108:111], a[84:87], a[32:35], v[108:111]
    v_add_f32 v10, v10, v18
    v_add_f32 v11, v11, v19
    v_mfma_f32_16x16x32_bf16 v[108:111], a[104:107], a[36:39], v[108:111]
    v_add_f32 v64, v64, v72
    v_mfma_f32_16x16x32_bf16 v[108:111], a[124:127], a[40:43], v[108:111]
    v_add_f32 v65, v65, v73
    v_mfma_f32_16x16x32_bf16 v[108:111], a[144:147], a[44:47], v[108:111]
    v_add_f32 v66, v66, v74
    v_add_f32 v67, v67, v75
    v_mfma_f32_16x16x32_bf16 v[112:115], a[48:51], a[24:27], v[112:115]
    v_add_f32 v68, v68, v76
    v_mfma_f32_16x16x32_bf16 v[112:115], a[68:71], a[28:31], v[112:115]
    v_add_f32 v69, v69, v77
    v_add_f32 v70, v70, v78
    v_mfma_f32_16x16x32_bf16 v[112:115], a[88:91], a[32:35], v[112:115]
    v_add_f32 v71, v71, v79
    v_mfma_f32_16x16x32_bf16 v[112:115], a[108:111], a[36:39], v[112:115]
    ds_write_b128 v20, v[108:111] offset:21504
    v_mfma_f32_16x16x32_bf16 v[112:115], a[128:131], a[40:43], v[112:115]
    v_add_f32 v4, v4, v64
    v_add_f32 v5, v5, v65
    v_mfma_f32_16x16x32_bf16 v[112:115], a[148:151], a[44:47], v[112:115]
    v_add_f32 v6, v6, v66
    v_add_f32 v7, v7, v67
    v_mfma_f32_16x16x32_bf16 v[116:119], a[52:55], a[24:27], v[116:119]
    v_add_f32 v8, v8, v68
    v_add_f32 v9, v9, v69
    v_mfma_f32_16x16x32_bf16 v[116:119], a[72:75], a[28:31], v[116:119]
    v_add_f32 v10, v10, v70
    v_mfma_f32_16x16x32_bf16 v[116:119], a[92:95], a[32:35], v[116:119]
    v_add_f32 v11, v11, v71
    v_mfma_f32_16x16x32_bf16 v[116:119], a[112:115], a[36:39], v[116:119]
    ds_write_b128 v20, v[112:115] offset:21568
    v_mfma_f32_16x16x32_bf16 v[116:119], a[132:135], a[40:43], v[116:119]
    v_fma_f32 v4, v4, v36, v80
    v_fma_f32 v5, v5, v36, v81
    v_mfma_f32_16x16x32_bf16 v[116:119], a[152:155], a[44:47], v[116:119]
    v_fma_f32 v6, v6, v36, v82
    v_fma_f32 v7, v7, v36, v83
    v_mfma_f32_16x16x32_bf16 v[120:123], a[56:59], a[24:27], v[120:123]
    v_fma_f32 v8, v8, v36, v84
    v_fma_f32 v9, v9, v36, v85
    v_mfma_f32_16x16x32_bf16 v[120:123], a[76:79], a[28:31], v[120:123]
    v_fma_f32 v10, v10, v36, v86
    v_mfma_f32_16x16x32_bf16 v[120:123], a[96:99], a[32:35], v[120:123]
    v_fma_f32 v11, v11, v36, v87
    v_cvt_pk_bf16_f32 v40, v4, v5
    v_mfma_f32_16x16x32_bf16 v[120:123], a[116:119], a[36:39], v[120:123]
    ds_write_b128 v20, v[116:119] offset:21632
    v_mfma_f32_16x16x32_bf16 v[120:123], a[136:139], a[40:43], v[120:123]
    v_cvt_pk_bf16_f32 v41, v6, v7
    v_cvt_pk_bf16_f32 v42, v8, v9
    v_mfma_f32_16x16x32_bf16 v[120:123], a[156:159], a[44:47], v[120:123]
    v_cvt_pk_bf16_f32 v43, v10, v11
    v_mfma_f32_16x16x32_bf16 v[124:127], a[60:63], a[24:27], v[124:127]
    s_add_u32 s45, s47, 81920
    buffer_store_dwordx4 v[40:43], v25, s[8:11], s45 offen nt
    v_mfma_f32_16x16x32_bf16 v[124:127], a[80:83], a[28:31], v[124:127]
    v_mfma_f32_16x16x32_bf16 v[124:127], a[100:103], a[32:35], v[124:127]
    v_mfma_f32_16x16x32_bf16 v[124:127], a[120:123], a[36:39], v[124:127]
    s_nop 0
    ds_write_b128 v20, v[120:123] offset:21696
    v_mfma_f32_16x16x32_bf16 v[124:127], a[140:143], a[40:43], v[124:127]
    v_mfma_f32_16x16x32_bf16 v[124:127], a[160:163], a[44:47], v[124:127]
    s_nop 7
    ds_write_b128 v20, v[124:127] offset:21760
    s_waitcnt lgkmcnt(0)
    s_barrier
    ds_read_b32 v36, v23 offset:768
    ds_read_b128 v[4:7], v21 offset:21504
    ds_read_b128 v[8:11], v21 offset:21520
    ds_read_b128 v[12:15], v21 offset:26880
    ds_read_b128 v[16:19], v21 offset:26896
    ds_read_b128 v[64:67], v21 offset:32256
    ds_read_b128 v[68:71], v21 offset:32272
    ds_read_b128 v[72:75], v21 offset:37632
    ds_read_b128 v[76:79], v21 offset:37648
    ds_read_b128 v[80:83], v22 offset:16128
    ds_read_b128 v[84:87], v22 offset:16144
    s_waitcnt lgkmcnt(7)
    v_add_f32 v4, v4, v12
    v_add_f32 v5, v5, v13
    v_add_f32 v6, v6, v14
    v_add_f32 v7, v7, v15
    s_waitcnt lgkmcnt(6)
    v_add_f32 v8, v8, v16
    v_add_f32 v9, v9, v17
    v_add_f32 v10, v10, v18
    v_add_f32 v11, v11, v19
    s_waitcnt lgkmcnt(3)
    v_add_f32 v64, v64, v72
    v_add_f32 v65, v65, v73
    v_add_f32 v66, v66, v74
    v_add_f32 v67, v67, v75
    s_waitcnt lgkmcnt(2)
    v_add_f32 v68, v68, v76
    v_add_f32 v69, v69, v77
    v_add_f32 v70, v70, v78
    v_add_f32 v71, v71, v79
    v_add_f32 v4, v4, v64
    v_add_f32 v5, v5, v65
    v_add_f32 v6, v6, v66
    v_add_f32 v7, v7, v67
    v_add_f32 v8, v8, v68
    v_add_f32 v9, v9, v69
    v_add_f32 v10, v10, v70
    v_add_f32 v11, v11, v71
    s_waitcnt lgkmcnt(1)
    v_fma_f32 v4, v4, v36, v80
    v_fma_f32 v5, v5, v36, v81
    v_fma_f32 v6, v6, v36, v82
    v_fma_f32 v7, v7, v36, v83
    s_waitcnt lgkmcnt(0)
    v_fma_f32 v8, v8, v36, v84
    v_fma_f32 v9, v9, v36, v85
    v_fma_f32 v10, v10, v36, v86
    v_fma_f32 v11, v11, v36, v87
    v_cvt_pk_bf16_f32 v44, v4, v5
    v_cvt_pk_bf16_f32 v45, v6, v7
L_hop6:
    s_cbranch_execz L_hopret
    v_cvt_pk_bf16_f32 v46, v8, v9
    v_cvt_pk_bf16_f32 v47, v10, v11
    s_add_u32 s45, s47, 122880
    buffer_store_dwordx4 v[44:47], v25, s[8:11], s45 offen nt
L_fin:
    s_endpgm
L_g0:
    s_mov_b32 s60, 0
L_gl0:
    buffer_load_dword v24, v19, s[4:7], s62 offen sc1
    s_add_u32 s60, s60, 1
    s_cmp_gt_u32 s60, 400000
    s_cbranch_scc1 L_gx0
    s_waitcnt vmcnt(0)
    v_cmp_ne_u32 vcc, s24, v24
    s_nop 1
    s_cbranch_vccnz L_gl0
    s_branch L_gx0
L_fb1:
    s_mov_b32 s60, 0
L_fbl1:
    buffer_load_dword v24, v56, s[4:7], s63 offen sc1
    s_add_u32 s60, s60, 1
    s_cmp_gt_u32 s60, 400000
    s_cbranch_scc1 L_fbx1
    s_waitcnt vmcnt(0)
    v_cmp_ne_u32 vcc, s24, v24
    s_nop 1
    s_cbranch_vccnz L_fbl1
    s_branch L_fbx1
L_g2:
    s_mov_b32 s60, 0
L_gl2:
    buffer_load_dword v44, v56, s[4:7], s62 offen sc1
    s_add_u32 s60, s60, 1
    s_cmp_gt_u32 s60, 400000
    s_cbranch_scc1 L_gx2
    s_waitcnt vmcnt(0)
    v_cmp_ne_u32 vcc, s24, v44
    s_nop 1
    s_cbranch_vccnz L_gl2
    s_branch L_gx2
L_g3:
    s_mov_b32 s60, 0
L_gl3:
    buffer_load_dword v124, v56, s[4:7], s62 offen sc1
    s_add_u32 s60, s60, 1
    s_cmp_gt_u32 s60, 400000
    s_cbranch_scc1 L_gx3
    s_waitcnt vmcnt(0)
    v_cmp_ne_u32 vcc, s24, v124
    s_nop 1
    s_cbranch_vccnz L_gl3
    s_branch L_gx3
L_slow4:
    s_mov_b32 s60, 0
L_slowl4:
    buffer_load_dword v30, v26, s[4:7], 0 offen sc1
    s_add_u32 s60, s60, 1
    s_cmp_gt_u32 s60, 400000
    s_cbranch_scc1 L_back4
    s_waitcnt vmcnt(0)
    v_subrev_u32 v30, s32, v30
    v_cmp_lt_u32 vcc, 3, v30
    s_nop 1
    s_cbranch_vccnz L_slowl4
    s_branch L_back4
L_slow5:
    s_mov_b32 s60, 0
L_slowl5:
    buffer_load_dword v30, v26, s[4:7], 0 offen sc1
    s_add_u32 s60, s60, 1
    s_cmp_gt_u32 s60, 400000
    s_cbranch_scc1 L_back5
    s_waitcnt vmcnt(0)
    v_subrev_u32 v30, s33, v30
    v_cmp_lt_u32 vcc, 2, v30
    s_nop 1
    s_cbranch_vccnz L_slowl5
    s_branch L_back5
L_slow6:
    s_mov_b32 s60, 0
L_slowl6:
    buffer_load_dword v30, v26, s[4:7], 0 offen sc1
    s_add_u32 s60, s60, 1
    s_cmp_gt_u32 s60, 400000
    s_cbranch_scc1 L_back6
    s_waitcnt vmcnt(0)
    v_subrev_u32 v30, s34, v30
    v_cmp_lt_u32 vcc, 1, v30
    s_nop 1
    s_cbranch_vccnz L_slowl6
    s_branch L_back6
L_slow7:
    s_mov_b32 s60, 0
L_slowl7:
    buffer_load_dword v30, v26, s[4:7], 0 offen sc1
    s_add_u32 s60, s60, 1
    s_cmp_gt_u32 s60, 400000
    s_cbranch_scc1 L_back7
    s_waitcnt vmcnt(0)
    v_subrev_u32 v30, s35, v30
    v_cmp_lt_u32 vcc, 0, v30
    s_nop 1
    s_cbranch_vccnz L_slowl7
    s_branch L_back7
L_end:
    s_endpgm
.section .rodata,"a"
.p2align 6
.amdhsa_kernel sequential_preLN__sliding_local_dilated__glu_gated_swiglu__prompt_kernel
  .amdhsa_next_free_vgpr 512
  .amdhsa_next_free_sgpr 102
  .amdhsa_accum_offset 256
  .amdhsa_group_segment_fixed_size 0
  .amdhsa_kernarg_size 80
  .amdhsa_user_sgpr_count 2
  .amdhsa_user_sgpr_kernarg_segment_ptr 1
  .amdhsa_system_sgpr_workgroup_id_x 1
.end_amdhsa_kernel
```
